```python
import torch

def _softmax(x, axis=-1):
    return torch.softmax(x, dim=axis)
def _gelu(x):
    return torch.nn.functional.gelu(x, approximate="tanh")
def _silu(x):
    return torch.nn.functional.silu(x)
def _sigmoid(x):
    return torch.sigmoid(x)
def _layernorm(x, axis=-1, eps=1e-5):
    m = x.mean(dim=axis, keepdim=True)
    v = x.var(dim=axis, keepdim=True, unbiased=False)
    return (x - m) / torch.sqrt(v + eps)
def _scatter_add(tgt, idx, src, axis=0):
    return tgt.clone().index_add_(axis, idx, src)
def _segment_sum(src, seg, n):
    out = torch.zeros((n,) + src.shape[1:], dtype=src.dtype)
    return out.index_add_(0, seg, src)
def _pad(x, pw):
    flat = tuple(v for pair in reversed(pw) for v in pair)
    return torch.nn.functional.pad(x, flat)

kernel_name = 'standalone__linear_kernel_rfa__prompt'

def setup_inputs():

    _w = (lambda a: (lambda t: t.to(torch.bfloat16) if t.is_floating_point() else t)(torch.as_tensor(a)))
    B, H, Sq, Sk, D, M = 1, 32, 2048, 2048, 192, 16
    return {
        "q": _w((lambda *s: torch.randn(*s, dtype=torch.bfloat16) * 0.1)(B, H, Sq, D)),
        "k": _w((lambda *s: torch.randn(*s, dtype=torch.bfloat16) * 1.6)(B, H, Sk, D)),
        "v": _w((lambda *s: torch.randn(*s, dtype=torch.bfloat16) * 1.6)(B, H, Sk, D)),
        "omega": _w((lambda *s: torch.randn(*s, dtype=torch.bfloat16) * 1.6)(M, D)),
    }

def reference(q, k, v, omega):
    d = q.shape[-1]
    m = omega.shape[0]
    scale = float(d) ** -0.25
    qs = q * scale
    ks = k * scale
    q_proj = torch.einsum("bhsd,md->bhsm", qs, omega)
    k_proj = torch.einsum("bhsd,md->bhsm", ks, omega)
    q_sq = 0.5 * torch.einsum("bhsd,bhsd->bhs", qs, qs)[..., None]
    k_sq = 0.5 * torch.einsum("bhsd,bhsd->bhs", ks, ks)[..., None]
    inv_sqrt_m = float(m) ** -0.5
    phi_q = torch.exp(q_proj - q_sq) * inv_sqrt_m + 1e-6
    phi_k = torch.exp(k_proj - k_sq) * inv_sqrt_m + 1e-6
    kv = torch.einsum("bhsm,bhsd->bhmd", phi_k, v)
    z  = torch.einsum("bhsm->bhm", phi_k)
    num = torch.einsum("bhqm,bhmd->bhqd", phi_q, kv)
    den = torch.einsum("bhqm,bhm->bhq", phi_q, z)[..., None] + 1e-6
    return num / den
```

```asm
; @launch grid=(256,1,1) block=(512,1,1) lds=154368
.amdgcn_target "amdgcn-amd-amdhsa--gfx950"
.text
.globl standalone__linear_kernel_rfa__prompt_kernel
.p2align 8
.type standalone__linear_kernel_rfa__prompt_kernel,@function
standalone__linear_kernel_rfa__prompt_kernel:
    s_cmp_ge_u32 s2, 256
    s_cbranch_scc1 L_end
    v_lshrrev_b32 v14, 6, v0
    v_and_b32 v1, 63, v0
    v_readfirstlane_b32 s48, v14
    v_mov_b32 v4, 154112
    v_mov_b32 v18, 0
    s_cmp_lg_u32 s48, 1
    s_nop 0
    s_cbranch_scc1 L_karg
    v_lshl_add_u32 v15, v1, 2, v4
    ds_write_b32 v15, v18
    s_waitcnt lgkmcnt(0)
L_karg:
    s_load_dwordx8 s[4:11], s[0:1], 0
    s_load_dwordx4 s[12:15], s[0:1], 32
    s_load_dwordx2 s[16:17], s[0:1], 48
    s_barrier
    v_lshrrev_b32 v14, 3, v1
    v_xor_b32 v2, v14, v1
    v_lshlrev_b32 v2, 4, v2
    s_and_b32 s52, s2, 7
    s_lshr_b32 s53, s2, 3
    s_lshl_b32 s52, s52, 5
    s_add_u32 s52, s52, s53
    s_lshr_b32 s50, s52, 3
    s_and_b32 s51, s52, 7
    s_mul_i32 s49, s52, 98304
    s_mov_b32 s66, 0
    s_cmp_lg_u32 s48, 0
    s_cbranch_scc1 L_REST
    s_setprio 3
    s_mov_b32 s53, 32768
    s_mov_b32 s26, 25165824
    s_mov_b32 s27, 0x20000
    s_mov_b32 s34, 6144
    s_mov_b32 s35, 0x20000
    s_mov_b32 s67, s49
    s_mov_b32 s54, 4096
    s_mov_b32 m0, 139264
    s_waitcnt lgkmcnt(0)
    s_mov_b32 s32, s10
    s_and_b32 s33, s11, 0xffff
    buffer_load_dwordx4 v2, s[32:35], 0 offen offset:0 lds
    buffer_load_dwordx4 v2, s[32:35], 0 offen offset:1024 lds
    buffer_load_dwordx4 v2, s[32:35], 0 offen offset:2048 lds
    buffer_load_dwordx4 v2, s[32:35], 0 offen offset:3072 lds
    s_mov_b32 m0, 143360
    s_nop 0
    buffer_load_dwordx4 v2, s[32:35], s54 offen offset:0 lds
    buffer_load_dwordx4 v2, s[32:35], s54 offen offset:1024 lds
    s_mov_b32 s24, s6
    s_and_b32 s25, s7, 0xffff
L_init:
    s_mov_b32 m0, s53
    s_add_u32 s53, s53, s54
    buffer_load_dwordx4 v2, s[24:27], s67 offen offset:0 nt lds
    buffer_load_dwordx4 v2, s[24:27], s67 offen offset:1024 nt lds
    buffer_load_dwordx4 v2, s[24:27], s67 offen offset:2048 nt lds
    buffer_load_dwordx4 v2, s[24:27], s67 offen offset:3072 nt lds
    s_add_u32 s67, s67, s54
    s_cmp_lt_u32 s53, 53248
    s_cbranch_scc1 L_init
    s_mov_b32 s28, s8
    s_and_b32 s29, s9, 0xffff
    s_mov_b32 s30, 25165824
    s_mov_b32 s31, 0x20000
    s_mov_b32 s20, s4
    s_and_b32 s21, s5, 0xffff
    s_mov_b32 s22, 25165824
    s_mov_b32 s23, 0x20000
    v_lshlrev_b32 v16, 8, v14
    v_add_u32 v16, v16, v2
    v_add_u32 v17, 2048, v16
    s_mov_b32 s8, 53248
L_ld_1:
    s_mov_b32 m0, s8
    s_add_u32 s8, s8, 2048
    buffer_load_dwordx4 v2, s[24:27], s67 offen nt lds
    buffer_load_dwordx4 v2, s[24:27], s67 offen offset:1024 nt lds
    v_add_u32 v18, 2, v18
    s_add_u32 s67, s67, 2048
    s_cmp_lt_u32 s8, 131072
    s_waitcnt vmcnt(20)
    ds_write_b32 v4, v18 offset:48
    s_cbranch_scc1 L_ld_1
    s_mov_b32 s8, 0
    s_add_u32 s67, s49, 0
L_ld_2:
    s_mov_b32 m0, s8
    s_add_u32 s8, s8, 2048
    buffer_load_dwordx4 v16, s[28:31], s67 offen nt lds
    buffer_load_dwordx4 v17, s[28:31], s67 offen offset:1024 nt lds
    v_add_u32 v18, 2, v18
    s_add_u32 s67, s67, 6144
    s_cmp_lt_u32 s8, 32768
    s_waitcnt vmcnt(20)
    ds_write_b32 v4, v18 offset:48
    s_cbranch_scc1 L_ld_2
L_w_3:
    ds_read_b128 v[96:99], v4 offset:16
    s_waitcnt lgkmcnt(0)
    v_min3_u32 v96, v96, v97, v98
    v_min_u32 v96, v96, v99
    s_nop 0
    v_readfirstlane_b32 s55, v96
    s_nop 0
    s_cmp_ge_u32 s55, 2
    s_nop 1
    s_cbranch_scc1 L_wd_4
    s_sleep 1
    s_add_u32 s66, s66, 1
    s_cmp_lt_u32 s66, 200000
    s_cbranch_scc1 L_w_3
L_wd_4:
    s_mov_b32 s8, 32768
    s_add_u32 s67, s49, 128
L_ld_5:
    s_mov_b32 m0, s8
    s_add_u32 s8, s8, 2048
    buffer_load_dwordx4 v16, s[28:31], s67 offen nt lds
    buffer_load_dwordx4 v17, s[28:31], s67 offen offset:1024 nt lds
    v_add_u32 v18, 2, v18
    s_add_u32 s67, s67, 6144
    s_cmp_lt_u32 s8, 65536
    s_waitcnt vmcnt(20)
    ds_write_b32 v4, v18 offset:48
    s_cbranch_scc1 L_ld_5
L_w_6:
    ds_read_b128 v[96:99], v4 offset:16
    s_waitcnt lgkmcnt(0)
    v_min3_u32 v96, v96, v97, v98
    v_min_u32 v96, v96, v99
    s_nop 0
    v_readfirstlane_b32 s55, v96
    s_nop 0
    s_cmp_ge_u32 s55, 4
    s_nop 1
    s_cbranch_scc1 L_wd_7
    s_sleep 1
    s_add_u32 s66, s66, 1
    s_cmp_lt_u32 s66, 200000
    s_cbranch_scc1 L_w_6
L_wd_7:
    s_mov_b32 s8, 98304
    s_add_u32 s67, s49, 256
L_sg0_0:
L_ld_8:
    s_mov_b32 m0, s8
    s_add_u32 s8, s8, 2048
    buffer_load_dwordx4 v16, s[28:31], s67 offen nt lds
    buffer_load_dwordx4 v17, s[28:31], s67 offen offset:1024 nt lds
    v_add_u32 v18, 2, v18
    s_add_u32 s67, s67, 6144
    s_cmp_lt_u32 s8, 131072
    s_waitcnt vmcnt(20)
    ds_write_b32 v4, v18 offset:48
    s_cbranch_scc1 L_ld_8
    ds_read_b32 v100, v4 offset:0
L_w_9:
    ds_read_b32 v14, v4 offset:56
    s_waitcnt lgkmcnt(0)
    v_readfirstlane_b32 s55, v14
    s_nop 0
    s_cmp_ge_u32 s55, 1
    s_nop 1
    s_cbranch_scc1 L_wd_10
    s_sleep 1
    s_add_u32 s66, s66, 1
    s_cmp_lt_u32 s66, 200000
    s_cbranch_scc1 L_w_9
L_wd_10:
    s_mov_b32 s8, 0
    s_mov_b32 s67, s49
    s_waitcnt lgkmcnt(0)
    v_readfirstlane_b32 s55, v100
    s_nop 0
    s_cmp_lg_u32 s55, 0
    s_nop 1
    s_cbranch_scc1 L_sw1_0
L_sg1_0:
L_ld_11:
    s_mov_b32 m0, s8
    s_add_u32 s8, s8, 2048
    buffer_load_dwordx4 v2, s[20:23], s67 offen nt lds
    buffer_load_dwordx4 v2, s[20:23], s67 offen offset:1024 nt lds
    v_add_u32 v18, 2, v18
    s_add_u32 s67, s67, 2048
    s_cmp_lt_u32 s8, 30720
    s_waitcnt vmcnt(20)
    ds_write_b32 v4, v18 offset:48
    s_cbranch_scc1 L_ld_11
    ds_read_b32 v100, v4 offset:0
L_w_12:
    ds_read_b32 v14, v4 offset:60
    s_waitcnt lgkmcnt(0)
    v_readfirstlane_b32 s55, v14
    s_nop 0
    s_cmp_ge_u32 s55, 1
    s_nop 1
    s_cbranch_scc1 L_wd_13
    s_sleep 1
    s_add_u32 s66, s66, 1
    s_cmp_lt_u32 s66, 200000
    s_cbranch_scc1 L_w_12
L_wd_13:
    s_waitcnt lgkmcnt(0)
    v_readfirstlane_b32 s55, v100
    s_nop 0
    s_cmp_lg_u32 s55, 0
    s_nop 1
    s_cbranch_scc1 L_sw2_0
L_sg2_0:
L_ld_14:
    s_mov_b32 m0, s8
    s_add_u32 s8, s8, 2048
    buffer_load_dwordx4 v2, s[20:23], s67 offen nt lds
    buffer_load_dwordx4 v2, s[20:23], s67 offen offset:1024 nt lds
    v_add_u32 v18, 2, v18
    s_add_u32 s67, s67, 2048
    s_cmp_lt_u32 s8, 61440
    s_waitcnt vmcnt(20)
    ds_write_b32 v4, v18 offset:48
    s_cbranch_scc1 L_ld_14
    ds_read_b32 v100, v4 offset:0
    s_waitcnt lgkmcnt(0)
    v_readfirstlane_b32 s55, v100
    s_nop 0
    s_cmp_lg_u32 s55, 0
    s_nop 1
    s_cbranch_scc1 L_sw3_0
L_sg3_0:
L_ld_15:
    s_mov_b32 m0, s8
    s_add_u32 s8, s8, 2048
    buffer_load_dwordx4 v2, s[20:23], s67 offen nt lds
    buffer_load_dwordx4 v2, s[20:23], s67 offen offset:1024 nt lds
    v_add_u32 v18, 2, v18
    s_add_u32 s67, s67, 2048
    s_cmp_lt_u32 s8, 83968
    s_waitcnt vmcnt(20)
    ds_write_b32 v4, v18 offset:48
    s_cbranch_scc1 L_ld_15
L_ld_16:
    s_mov_b32 m0, s8
    s_add_u32 s8, s8, 2048
    buffer_load_dwordx4 v2, s[20:23], s67 offen nt lds
    buffer_load_dwordx4 v2, s[20:23], s67 offen offset:1024 nt lds
    s_add_u32 s67, s67, 2048
    s_cmp_lt_u32 s8, 98304
    s_cbranch_scc1 L_ld_16
    v_add_u32 v18, 4, v18
    s_waitcnt vmcnt(30)
    ds_write_b32 v4, v18 offset:48
    v_add_u32 v18, 6, v18
    s_waitcnt vmcnt(24)
    ds_write_b32 v4, v18 offset:48
    v_add_u32 v18, 6, v18
    s_waitcnt vmcnt(18)
    ds_write_b32 v4, v18 offset:48
    v_add_u32 v18, 6, v18
    s_waitcnt vmcnt(12)
    ds_write_b32 v4, v18 offset:48
    v_add_u32 v18, 6, v18
    s_waitcnt vmcnt(6)
    ds_write_b32 v4, v18 offset:48
    v_add_u32 v18, 6, v18
    s_waitcnt vmcnt(0)
    ds_write_b32 v4, v18 offset:48
    s_branch L_ldone
L_sg1_1:
L_ld_17:
    s_mov_b32 m0, s8
    s_add_u32 s8, s8, 2048
    buffer_load_dwordx4 v2, s[20:23], s67 offen nt lds
    buffer_load_dwordx4 v2, s[20:23], s67 offen offset:1024 nt lds
    v_add_u32 v18, 2, v18
    s_add_u32 s67, s67, 2048
    s_cmp_lt_u32 s8, 30720
    s_waitcnt vmcnt(32)
    ds_write_b32 v4, v18 offset:48
    s_cbranch_scc1 L_ld_17
    ds_read_b32 v100, v4 offset:0
L_w_18:
    ds_read_b32 v14, v4 offset:60
    s_waitcnt lgkmcnt(0)
    v_readfirstlane_b32 s55, v14
    s_nop 0
    s_cmp_ge_u32 s55, 1
    s_nop 1
    s_cbranch_scc1 L_wd_19
    s_sleep 1
    s_add_u32 s66, s66, 1
    s_cmp_lt_u32 s66, 200000
    s_cbranch_scc1 L_w_18
L_wd_19:
    s_waitcnt lgkmcnt(0)
    v_readfirstlane_b32 s55, v100
    s_nop 0
    s_cmp_lg_u32 s55, 1
    s_nop 1
    s_cbranch_scc1 L_sw2_1
L_sg2_1:
L_ld_20:
    s_mov_b32 m0, s8
    s_add_u32 s8, s8, 2048
    buffer_load_dwordx4 v2, s[20:23], s67 offen nt lds
    buffer_load_dwordx4 v2, s[20:23], s67 offen offset:1024 nt lds
    v_add_u32 v18, 2, v18
    s_add_u32 s67, s67, 2048
    s_cmp_lt_u32 s8, 61440
    s_waitcnt vmcnt(32)
    ds_write_b32 v4, v18 offset:48
    s_cbranch_scc1 L_ld_20
    ds_read_b32 v100, v4 offset:0
    s_waitcnt lgkmcnt(0)
    v_readfirstlane_b32 s55, v100
    s_nop 0
    s_cmp_lg_u32 s55, 1
    s_nop 1
    s_cbranch_scc1 L_sw3_1
L_sg3_1:
L_ld_21:
    s_mov_b32 m0, s8
    s_add_u32 s8, s8, 2048
    buffer_load_dwordx4 v2, s[20:23], s67 offen nt lds
    buffer_load_dwordx4 v2, s[20:23], s67 offen offset:1024 nt lds
    v_add_u32 v18, 2, v18
    s_add_u32 s67, s67, 2048
    s_cmp_lt_u32 s8, 83968
    s_waitcnt vmcnt(32)
    ds_write_b32 v4, v18 offset:48
    s_cbranch_scc1 L_ld_21
L_ld_22:
    s_mov_b32 m0, s8
    s_add_u32 s8, s8, 2048
    buffer_load_dwordx4 v2, s[20:23], s67 offen nt lds
    buffer_load_dwordx4 v2, s[20:23], s67 offen offset:1024 nt lds
    s_add_u32 s67, s67, 2048
    s_cmp_lt_u32 s8, 98304
    s_cbranch_scc1 L_ld_22
    v_add_u32 v18, 4, v18
    s_waitcnt vmcnt(42)
    ds_write_b32 v4, v18 offset:48
    v_add_u32 v18, 6, v18
    s_waitcnt vmcnt(36)
    ds_write_b32 v4, v18 offset:48
    v_add_u32 v18, 6, v18
    s_waitcnt vmcnt(30)
    ds_write_b32 v4, v18 offset:48
    v_add_u32 v18, 6, v18
    s_waitcnt vmcnt(24)
    ds_write_b32 v4, v18 offset:48
    v_add_u32 v18, 6, v18
    s_waitcnt vmcnt(18)
    ds_write_b32 v4, v18 offset:48
    v_add_u32 v18, 6, v18
    s_waitcnt vmcnt(12)
    ds_write_b32 v4, v18 offset:48
    v_add_u32 v18, 6, v18
    s_waitcnt vmcnt(6)
    ds_write_b32 v4, v18 offset:48
    v_add_u32 v18, 6, v18
    s_waitcnt vmcnt(0)
    ds_write_b32 v4, v18 offset:48
    s_branch L_ldone
L_sw1_0:
L_ld_23:
    s_mov_b32 m0, s8
    s_add_u32 s8, s8, 2048
    buffer_load_dwordx4 v2, s[20:23], s67 offen nt lds
    buffer_load_dwordx4 v2, s[20:23], s67 offen offset:1024 nt lds
    s_add_u32 s67, s67, 2048
    s_cmp_lt_u32 s8, 12288
    s_cbranch_scc1 L_ld_23
    s_branch L_sg1_1
L_sw2_0:
L_ld_24:
    s_mov_b32 m0, s8
    s_add_u32 s8, s8, 2048
    buffer_load_dwordx4 v2, s[20:23], s67 offen nt lds
    buffer_load_dwordx4 v2, s[20:23], s67 offen offset:1024 nt lds
    s_add_u32 s67, s67, 2048
    s_cmp_lt_u32 s8, 43008
    s_cbranch_scc1 L_ld_24
    s_branch L_sg2_1
L_sw2_1:
    v_add_u32 v18, 2, v18
    s_waitcnt vmcnt(30)
    ds_write_b32 v4, v18 offset:48
    v_add_u32 v18, 6, v18
    s_waitcnt vmcnt(24)
    ds_write_b32 v4, v18 offset:48
    v_add_u32 v18, 4, v18
    s_waitcnt vmcnt(20)
    ds_write_b32 v4, v18 offset:48
    s_branch L_sg2_0
L_sw3_0:
L_ld_25:
    s_mov_b32 m0, s8
    s_add_u32 s8, s8, 2048
    buffer_load_dwordx4 v2, s[20:23], s67 offen nt lds
    buffer_load_dwordx4 v2, s[20:23], s67 offen offset:1024 nt lds
    s_add_u32 s67, s67, 2048
    s_cmp_lt_u32 s8, 73728
    s_cbranch_scc1 L_ld_25
    s_branch L_sg3_1
L_sw3_1:
    v_add_u32 v18, 2, v18
    s_waitcnt vmcnt(30)
    ds_write_b32 v4, v18 offset:48
    v_add_u32 v18, 6, v18
    s_waitcnt vmcnt(24)
    ds_write_b32 v4, v18 offset:48
    v_add_u32 v18, 4, v18
    s_waitcnt vmcnt(20)
    ds_write_b32 v4, v18 offset:48
    s_branch L_sg3_0
L_ldone:
    s_branch L_fin
L_REST:
    v_and_b32 v14, 15, v1
    v_lshrrev_b32 v15, 4, v1
    v_mul_u32_u24 v3, 1536, v15
    v_lshl_add_u32 v3, v14, 3, v3
    v_lshlrev_b32 v5, 4, v1
    v_lshlrev_b32 v94, 3, v1
    v_lshlrev_b32 v95, 4, v15
    s_mov_b32 s60, 0xffff0000
    s_cmp_ge_u32 s48, 5
    s_cbranch_scc1 L_V
    v_mov_b32 v100, 0x358637bd
    v_mov_b32 v101, 0x358637bd
    s_sub_u32 s3, s48, 1
    s_mov_b32 s56, 0x3e898b82
    s_mov_b32 s57, 0x3e898b82
    s_mov_b32 s58, 0x3fb8aa3b
    s_mov_b32 s59, 0x3fb8aa3b
    s_mov_b32 s64, 0x3e800000
    s_mov_b32 s65, 0x3e800000
    v_lshlrev_b32 v84, 2, v15
    v_sub_u32 v84, v14, v84
    v_mov_b32 v85, 0xffff
    v_mov_b32 v86, s60
    v_mov_b32 v87, 0
    v_cmp_eq_u32 vcc, 0, v84
    s_nop 1
    v_cndmask_b32 v6, v87, v85, vcc
    v_cmp_eq_u32 vcc, 1, v84
    s_nop 1
    v_cndmask_b32 v6, v6, v86, vcc
    v_cmp_eq_u32 vcc, 2, v84
    s_nop 1
    v_cndmask_b32 v7, v87, v85, vcc
    v_cmp_eq_u32 vcc, 3, v84
    s_nop 1
    v_cndmask_b32 v7, v7, v86, vcc
    v_and_b32 v16, 0x3f803f80, v6
    v_and_b32 v17, 0x3f803f80, v7
    v_mov_b32 v18, 0xbf00bf00
    v_mov_b32 v19, 0xbf00bf00
    v_mul_u32_u24 v84, 3, v14
    v_add_u32 v85, 0, v84
    v_and_b32 v86, 7, v85
    v_xor_b32 v86, v86, v15
    v_lshlrev_b32 v86, 4, v86
    v_lshl_add_u32 v164, v85, 7, v86
    v_xor_b32 v165, 64, v164
    v_add_u32 v85, 1, v84
    v_and_b32 v86, 7, v85
    v_xor_b32 v86, v86, v15
    v_lshlrev_b32 v86, 4, v86
    v_lshl_add_u32 v166, v85, 7, v86
    v_xor_b32 v167, 64, v166
    v_add_u32 v85, 2, v84
    v_and_b32 v86, 7, v85
    v_xor_b32 v86, v86, v15
    v_lshlrev_b32 v86, 4, v86
    v_lshl_add_u32 v168, v85, 7, v86
    v_xor_b32 v169, 64, v168
    v_add_u32 v8, 139264, v164
    v_add_u32 v9, 139264, v165
    v_add_u32 v10, 139264, v166
    v_add_u32 v11, 139264, v167
    v_add_u32 v12, 139264, v168
    v_add_u32 v13, 139264, v169
    v_lshlrev_b32 v170, 5, v14
    v_lshl_add_u32 v170, v15, 3, v170
    s_lshl_b32 s54, s3, 9
    s_add_u32 s54, s54, 131072
    v_add_u32 v170, s54, v170
    s_lshl_b32 s54, s3, 2
    v_add_u32 v171, s54, v4
    s_mov_b32 s63, 24576
    s_mul_i32 s18, s3, 6
    s_waitcnt lgkmcnt(0)
    s_mov_b32 s44, s16
    s_and_b32 s45, s17, 0xffff
    s_mov_b32 s46, 268435456
    s_mov_b32 s47, 0x20000
    s_mov_b32 s36, s12
    s_and_b32 s37, s13, 0xffff
    s_mov_b32 s38, 25165824
    s_mov_b32 s39, 0x20000
    s_mul_i32 s8, s3, 6144
    s_add_u32 s53, s8, 32768
L_w_26:
    ds_read_b32 v14, v4 offset:48
    s_waitcnt lgkmcnt(0)
    v_readfirstlane_b32 s55, v14
    s_nop 0
    s_cmp_ge_u32 s55, 2
    s_nop 1
    s_cbranch_scc1 L_wd_27
    s_sleep 1
    s_add_u32 s66, s66, 1
    s_cmp_lt_u32 s66, 200000
    s_cbranch_scc1 L_w_26
L_wd_27:
    ds_read_b128 v[24:27], v8
    ds_read_b128 v[28:31], v9
    ds_read_b128 v[32:35], v10
    ds_read_b128 v[36:39], v11
    ds_read_b128 v[40:43], v12
    ds_read_b128 v[44:47], v13
    v_add_u32 v8, s53, v164
    v_add_u32 v9, s53, v165
    v_add_u32 v10, s53, v166
    v_add_u32 v11, s53, v167
    v_add_u32 v12, s53, v168
    v_add_u32 v13, s53, v169
    s_add_u32 s54, s18, 6
L_w_28:
    ds_read_b32 v14, v4 offset:48
    s_waitcnt lgkmcnt(0)
    v_readfirstlane_b32 s55, v14
    s_nop 0
    s_cmp_ge_u32 s55, s54
    s_nop 1
    s_cbranch_scc1 L_wd_29
    s_sleep 1
    s_add_u32 s66, s66, 1
    s_cmp_lt_u32 s66, 200000
    s_cbranch_scc1 L_w_28
L_wd_29:
    s_call_b64 s[68:69], L_PHI
    v_mov_b32 v14, 1
    ds_write_b64 v170, v[92:93] offset:0
    ds_write_b32 v171, v14 offset:16
    s_add_u32 s54, s18, 30
L_w_30:
    ds_read_b32 v14, v4 offset:48
    s_waitcnt lgkmcnt(0)
    v_readfirstlane_b32 s55, v14
    s_nop 0
    s_cmp_ge_u32 s55, s54
    s_nop 1
    s_cbranch_scc1 L_wd_31
    s_sleep 1
    s_add_u32 s66, s66, 1
    s_cmp_lt_u32 s66, 200000
    s_cbranch_scc1 L_w_30
L_wd_31:
    s_call_b64 s[68:69], L_PHI
    v_mov_b32 v14, 2
    ds_write_b64 v170, v[92:93] offset:2048
    ds_write_b32 v171, v14 offset:16
    s_add_u32 s54, s18, 54
L_w_32:
    ds_read_b32 v14, v4 offset:48
    s_waitcnt lgkmcnt(0)
    v_readfirstlane_b32 s55, v14
    s_nop 0
    s_cmp_ge_u32 s55, s54
    s_nop 1
    s_cbranch_scc1 L_wd_33
    s_sleep 1
    s_add_u32 s66, s66, 1
    s_cmp_lt_u32 s66, 200000
    s_cbranch_scc1 L_w_32
L_wd_33:
    s_call_b64 s[68:69], L_PHI
    v_mov_b32 v14, 3
    ds_write_b64 v170, v[92:93] offset:4096
    ds_write_b32 v171, v14 offset:16
    s_add_u32 s54, s18, 78
L_w_34:
    ds_read_b32 v14, v4 offset:48
    s_waitcnt lgkmcnt(0)
    v_readfirstlane_b32 s55, v14
    s_nop 0
    s_cmp_ge_u32 s55, s54
    s_nop 1
    s_cbranch_scc1 L_wd_35
    s_sleep 1
    s_add_u32 s66, s66, 1
    s_cmp_lt_u32 s66, 200000
    s_cbranch_scc1 L_w_34
L_wd_35:
    s_call_b64 s[68:69], L_PHI
    v_mov_b32 v14, 4
    ds_write_b64 v170, v[92:93] offset:6144
    ds_write_b32 v171, v14 offset:16
    v_add_u32 v8, s8, v164
    v_add_u32 v9, s8, v165
    v_add_u32 v10, s8, v166
    v_add_u32 v11, s8, v167
    v_add_u32 v12, s8, v168
    v_add_u32 v13, s8, v169
    s_lshl_b32 s54, s3, 10
    s_add_u32 s54, s54, 139264
    v_add_u32 v170, s54, v5
    s_add_u32 s61, s8, s49
    s_add_u32 s61, s61, 73728
    s_cmp_lg_u32 s3, 3
    s_cbranch_scc1 L_KQ_q
    s_lshl_b32 s52, s50, 13
    s_add_u32 s9, s52, 6144
    s_lshl_b32 s53, s51, 7
    s_add_u32 s6, s9, s53
    v_and_b32 v148, 7, v1
    v_lshl_add_u32 v148, v148, 7, v95
    v_mov_b32 v140, 0x3f803f80
    v_mov_b32 v141, 0x3f803f80
    v_mov_b32 v142, 0x3f803f80
    v_mov_b32 v143, 0x3f803f80
    v_add_u32 v15, 131072, v94
L_w_36:
    ds_read_b128 v[96:99], v4 offset:16
    s_waitcnt lgkmcnt(0)
    v_min3_u32 v96, v96, v97, v98
    v_min_u32 v96, v96, v99
    s_nop 0
    v_readfirstlane_b32 s55, v96
    s_nop 0
    s_cmp_ge_u32 s55, 4
    s_nop 1
    s_cbranch_scc1 L_wd_37
    s_sleep 1
    s_add_u32 s66, s66, 1
    s_cmp_lt_u32 s66, 200000
    s_cbranch_scc1 L_w_36
L_wd_37:
    ds_read_b64_tr_b16 v[104:105], v15 offset:0
    ds_read_b64_tr_b16 v[106:107], v15 offset:512
    ds_read_b64_tr_b16 v[108:109], v15 offset:1024
    ds_read_b64_tr_b16 v[110:111], v15 offset:1536
    ds_read_b64_tr_b16 v[112:113], v15 offset:2048
    ds_read_b64_tr_b16 v[114:115], v15 offset:2560
    ds_read_b64_tr_b16 v[116:117], v15 offset:3072
    ds_read_b64_tr_b16 v[118:119], v15 offset:3584
    ds_read_b64_tr_b16 v[120:121], v15 offset:4096
    ds_read_b64_tr_b16 v[122:123], v15 offset:4608
    ds_read_b64_tr_b16 v[124:125], v15 offset:5120
    ds_read_b64_tr_b16 v[126:127], v15 offset:5632
    ds_read_b64_tr_b16 v[128:129], v15 offset:6144
    ds_read_b64_tr_b16 v[130:131], v15 offset:6656
    ds_read_b64_tr_b16 v[132:133], v15 offset:7168
    ds_read_b64_tr_b16 v[134:135], v15 offset:7680
    s_waitcnt lgkmcnt(0)
    v_mfma_f32_16x16x32_bf16 v[136:139], v[104:107], v[140:143], 0
    v_mfma_f32_16x16x32_bf16 v[136:139], v[108:111], v[140:143], v[136:139]
    v_mfma_f32_16x16x32_bf16 v[136:139], v[112:115], v[140:143], v[136:139]
    v_mfma_f32_16x16x32_bf16 v[136:139], v[116:119], v[140:143], v[136:139]
    v_mfma_f32_16x16x32_bf16 v[136:139], v[120:123], v[140:143], v[136:139]
    v_mfma_f32_16x16x32_bf16 v[136:139], v[124:127], v[140:143], v[136:139]
    v_mfma_f32_16x16x32_bf16 v[136:139], v[128:131], v[140:143], v[136:139]
    v_mfma_f32_16x16x32_bf16 v[136:139], v[132:135], v[140:143], v[136:139]
L_w_38:
    ds_read_b32 v14, v4 offset:8
    s_waitcnt lgkmcnt(0)
    v_readfirstlane_b32 s55, v14
    s_nop 0
    s_cmp_ge_u32 s55, 2
    s_nop 1
    s_cbranch_scc1 L_wd_39
    s_sleep 2
    s_add_u32 s66, s66, 1
    s_cmp_lt_u32 s66, 200000
    s_cbranch_scc1 L_w_38
L_wd_39:
    s_mov_b32 s19, s55
    v_min_u32 v136, -2, v136
    v_min_u32 v137, -2, v137
    v_min_u32 v138, -2, v138
    v_min_u32 v139, -2, v139
    s_mov_b32 exec_lo, 0x00010001
    s_mov_b32 exec_hi, 0x00010001
    s_cmp_eq_u32 s19, 2
    s_cbranch_scc0 L_hs_40
    buffer_store_dwordx4 v[136:139], v95, s[44:47], s6 offen
    s_nop 0
    s_branch L_hd_41
L_hs_40:
    buffer_store_dwordx4 v[136:139], v95, s[44:47], s6 offen sc1
L_hd_41:
    s_mov_b64 exec, -1
    s_mov_b32 s54, s66
L_poll_42:
    buffer_load_dwordx4 v[232:235], v148, s[44:47], s9 offen sc1
    s_waitcnt vmcnt(0)
    v_max3_u32 v80, v232, v233, v234
    v_max_u32 v80, v80, v235
    v_add_f32_dpp v140, v232, v232 quad_perm:[1,0,3,2] row_mask:0xf bank_mask:0xf
    v_add_f32_dpp v141, v233, v233 quad_perm:[1,0,3,2] row_mask:0xf bank_mask:0xf
    v_add_f32_dpp v142, v234, v234 quad_perm:[1,0,3,2] row_mask:0xf bank_mask:0xf
    v_add_f32_dpp v143, v235, v235 quad_perm:[1,0,3,2] row_mask:0xf bank_mask:0xf
    v_cmp_eq_u32 vcc, -1, v80
    s_nop 0
    s_cmp_eq_u64 vcc, 0
    s_cselect_b32 s52, 1, 0
    s_cmp_lg_u32 s54, s66
    s_cbranch_scc1 L_lg_44
    v_mov_b32 v14, s52
    ds_write_b32 v4, v14 offset:0
L_lg_44:
    s_cmp_eq_u32 s52, 1
    s_cbranch_scc1 L_done_43
    s_add_u32 s66, s66, 1
    s_cmp_lt_u32 s66, 200000
    s_cbranch_scc1 L_poll_42
L_done_43:
    v_add_f32_dpp v140, v140, v140 quad_perm:[2,3,0,1] row_mask:0xf bank_mask:0xf
    v_add_f32_dpp v141, v141, v141 quad_perm:[2,3,0,1] row_mask:0xf bank_mask:0xf
    v_add_f32_dpp v142, v142, v142 quad_perm:[2,3,0,1] row_mask:0xf bank_mask:0xf
    v_add_f32_dpp v143, v143, v143 quad_perm:[2,3,0,1] row_mask:0xf bank_mask:0xf
    v_add_f32_dpp v140, v140, v140 row_half_mirror row_mask:0xf bank_mask:0xf
    v_add_f32_dpp v141, v141, v141 row_half_mirror row_mask:0xf bank_mask:0xf
    v_add_f32_dpp v142, v142, v142 row_half_mirror row_mask:0xf bank_mask:0xf
    v_add_f32_dpp v143, v143, v143 row_half_mirror row_mask:0xf bank_mask:0xf
    v_cvt_pk_bf16_f32 v144, v140, v141
    v_cvt_pk_bf16_f32 v145, v142, v143
    v_add_u32 v15, 153600, v94
    ds_write_b64 v15, v[144:145]
    v_mov_b32 v14, 1
    ds_write_b32 v4, v14 offset:4
L_KQ_q:
L_w_45:
    ds_read_b32 v14, v4 offset:4
    s_waitcnt lgkmcnt(0)
    v_readfirstlane_b32 s55, v14
    s_nop 0
    s_cmp_ge_u32 s55, 1
    s_nop 1
    s_cbranch_scc1 L_wd_46
    s_sleep 4
    s_add_u32 s66, s66, 1
    s_cmp_lt_u32 s66, 200000
    s_cbranch_scc1 L_w_45
L_wd_46:
    v_add_u32 v15, 153600, v94
    ds_read_b64 v[102:103], v15
    v_add_u32 v228, 147456, v5
    v_add_u32 v229, 8, v228
    s_mov_b32 s4, 0
    s_waitcnt vmcnt(0)
    s_sub_u32 s52, s61, 24576
    s_add_u32 s54, s18, 198
L_w_47:
    ds_read_b32 v14, v4 offset:48
    s_waitcnt lgkmcnt(0)
    v_readfirstlane_b32 s55, v14
    s_nop 0
    s_cmp_ge_u32 s55, s54
    s_nop 1
    s_cbranch_scc1 L_wd_48
    s_sleep 1
    s_add_u32 s66, s66, 1
    s_cmp_lt_u32 s66, 200000
    s_cbranch_scc1 L_w_47
L_wd_48:
    s_call_b64 s[68:69], L_PHI
    v_mfma_f32_16x16x16_bf16 v[72:75], v[102:103], v[92:93], 0
    v_lshlrev_b32 v80, 16, v92
    v_and_b32 v81, s60, v92
    v_lshlrev_b32 v82, 16, v93
    v_and_b32 v83, s60, v93
    v_mov_b32 v14, 1
    s_nop 2
    v_cvt_pk_bf16_f32 v84, v72, v72
    v_and_b32 v84, s60, v84
    v_add_f32 v84, v84, v100
    v_cvt_pk_bf16_f32 v84, v84, v84
    v_and_b32 v84, s60, v84
    v_rcp_f32 v84, v84
    s_nop 0
    v_mul_f32 v80, v80, v84
    v_mul_f32 v81, v81, v84
    v_mul_f32 v82, v82, v84
    v_mul_f32 v83, v83, v84
    v_cvt_pk_bf16_f32 v76, v80, v81
    v_cvt_pk_bf16_f32 v77, v82, v83
    v_lshlrev_b32 v84, 16, v76
    v_and_b32 v85, s60, v76
    v_lshlrev_b32 v86, 16, v77
    v_and_b32 v87, s60, v77
    v_sub_f32 v80, v80, v84
    v_sub_f32 v81, v81, v85
    v_sub_f32 v82, v82, v86
    v_sub_f32 v83, v83, v87
    v_cvt_pk_bf16_f32 v78, v80, v81
    v_cvt_pk_bf16_f32 v79, v82, v83
    ds_write_b128 v170, v[76:79] offset:0
    ds_write_b32 v171, v14 offset:32
    s_add_u32 s54, s18, 222
L_w_49:
    ds_read_b32 v14, v4 offset:48
    s_waitcnt lgkmcnt(0)
    v_readfirstlane_b32 s55, v14
    s_nop 0
    s_cmp_ge_u32 s55, s54
    s_nop 1
    s_cbranch_scc1 L_wd_50
    s_sleep 1
    s_add_u32 s66, s66, 1
    s_cmp_lt_u32 s66, 200000
    s_cbranch_scc1 L_w_49
L_wd_50:
    s_call_b64 s[68:69], L_PHI
    v_mfma_f32_16x16x16_bf16 v[72:75], v[102:103], v[92:93], 0
    v_lshlrev_b32 v80, 16, v92
    v_and_b32 v81, s60, v92
    v_lshlrev_b32 v82, 16, v93
    v_and_b32 v83, s60, v93
    v_mov_b32 v14, 2
    s_nop 2
    v_cvt_pk_bf16_f32 v84, v72, v72
    v_and_b32 v84, s60, v84
    v_add_f32 v84, v84, v100
    v_cvt_pk_bf16_f32 v84, v84, v84
    v_and_b32 v84, s60, v84
    v_rcp_f32 v84, v84
    s_nop 0
    v_mul_f32 v80, v80, v84
    v_mul_f32 v81, v81, v84
    v_mul_f32 v82, v82, v84
    v_mul_f32 v83, v83, v84
    v_cvt_pk_bf16_f32 v76, v80, v81
    v_cvt_pk_bf16_f32 v77, v82, v83
    v_lshlrev_b32 v84, 16, v76
    v_and_b32 v85, s60, v76
    v_lshlrev_b32 v86, 16, v77
    v_and_b32 v87, s60, v77
    v_sub_f32 v80, v80, v84
    v_sub_f32 v81, v81, v85
    v_sub_f32 v82, v82, v86
    v_sub_f32 v83, v83, v87
    v_cvt_pk_bf16_f32 v78, v80, v81
    v_cvt_pk_bf16_f32 v79, v82, v83
    ds_write_b128 v170, v[76:79] offset:4096
    ds_write_b32 v171, v14 offset:32
    s_add_u32 s54, s18, 246
L_w_51:
    ds_read_b32 v14, v4 offset:48
    s_waitcnt lgkmcnt(0)
    v_readfirstlane_b32 s55, v14
    s_nop 0
    s_cmp_ge_u32 s55, s54
    s_nop 1
    s_cbranch_scc1 L_wd_52
    s_sleep 1
    s_add_u32 s66, s66, 1
    s_cmp_lt_u32 s66, 200000
    s_cbranch_scc1 L_w_51
L_wd_52:
    s_call_b64 s[68:69], L_PHI
    v_mfma_f32_16x16x16_bf16 v[72:75], v[102:103], v[92:93], 0
    v_lshlrev_b32 v80, 16, v92
    v_and_b32 v81, s60, v92
    v_lshlrev_b32 v82, 16, v93
    v_and_b32 v83, s60, v93
    s_nop 3
    v_cvt_pk_bf16_f32 v84, v72, v72
    v_and_b32 v84, s60, v84
    v_add_f32 v84, v84, v100
    v_cvt_pk_bf16_f32 v84, v84, v84
    v_and_b32 v84, s60, v84
    v_rcp_f32 v84, v84
    s_nop 0
    v_mul_f32 v80, v80, v84
    v_mul_f32 v81, v81, v84
    v_mul_f32 v82, v82, v84
    v_mul_f32 v83, v83, v84
    v_cvt_pk_bf16_f32 v152, v80, v81
    v_cvt_pk_bf16_f32 v153, v82, v83
    v_lshlrev_b32 v84, 16, v152
    v_and_b32 v85, s60, v152
    v_lshlrev_b32 v86, 16, v153
    v_and_b32 v87, s60, v153
    v_sub_f32 v80, v80, v84
    v_sub_f32 v81, v81, v85
    v_sub_f32 v82, v82, v86
    v_sub_f32 v83, v83, v87
    v_cvt_pk_bf16_f32 v154, v80, v81
    v_cvt_pk_bf16_f32 v155, v82, v83
    s_add_u32 s54, s18, 270
L_K3:
    ds_read2_b32 v[96:97], v4 offset0:3 offset1:12
    s_waitcnt lgkmcnt(0)
    v_readfirstlane_b32 s53, v96
    v_readfirstlane_b32 s55, v97
    s_cmp_lg_u32 s4, 0
    s_nop 2
    s_cbranch_scc1 L_K3a
    s_cmp_lt_u32 s53, 3
    s_cbranch_scc1 L_K3b
    s_call_b64 s[6:7], L_B8
L_K3a:
    s_cmp_lg_u32 s4, 1
    s_cbranch_scc1 L_K3b
    s_cmp_lt_u32 s55, 268
    s_cbranch_scc1 L_K3b
    s_mov_b32 s4, 2
    buffer_store_dwordx2 v[232:233], v3, s[36:39], s52 offen offset:0 nt
    buffer_store_dwordx2 v[234:235], v3, s[36:39], s52 offen offset:384 nt
    buffer_store_dwordx2 v[236:237], v3, s[36:39], s52 offen offset:768 nt
    buffer_store_dwordx2 v[238:239], v3, s[36:39], s52 offen offset:1152 nt
    buffer_store_dwordx2 v[240:241], v3, s[36:39], s52 offen offset:128 nt
    buffer_store_dwordx2 v[242:243], v3, s[36:39], s52 offen offset:512 nt
    buffer_store_dwordx2 v[244:245], v3, s[36:39], s52 offen offset:896 nt
    buffer_store_dwordx2 v[246:247], v3, s[36:39], s52 offen offset:1280 nt
    buffer_store_dwordx2 v[248:249], v3, s[36:39], s52 offen offset:256 nt
    buffer_store_dwordx2 v[250:251], v3, s[36:39], s52 offen offset:640 nt
    buffer_store_dwordx2 v[252:253], v3, s[36:39], s52 offen offset:1024 nt
    buffer_store_dwordx2 v[254:255], v3, s[36:39], s52 offen offset:1408 nt
L_K3b:
    s_cmp_ge_u32 s55, s54
    s_cbranch_scc1 L_K3d
    s_sleep 1
    s_add_u32 s66, s66, 1
    s_cmp_lt_u32 s66, 200000
    s_cbranch_scc1 L_K3
L_K3d:
    s_call_b64 s[68:69], L_PHI
    ds_read_b32 v15, v4 offset:12
    v_mfma_f32_16x16x16_bf16 v[72:75], v[102:103], v[92:93], 0
    v_lshlrev_b32 v80, 16, v92
    v_and_b32 v81, s60, v92
    v_lshlrev_b32 v82, 16, v93
    v_and_b32 v83, s60, v93
    s_nop 3
    v_cvt_pk_bf16_f32 v84, v72, v72
    v_and_b32 v84, s60, v84
    v_add_f32 v84, v84, v100
    v_cvt_pk_bf16_f32 v84, v84, v84
    v_and_b32 v84, s60, v84
    v_rcp_f32 v84, v84
    s_nop 0
    v_mul_f32 v80, v80, v84
    v_mul_f32 v81, v81, v84
    v_mul_f32 v82, v82, v84
    v_mul_f32 v83, v83, v84
    v_cvt_pk_bf16_f32 v76, v80, v81
    v_cvt_pk_bf16_f32 v77, v82, v83
    v_lshlrev_b32 v84, 16, v76
    v_and_b32 v85, s60, v76
    v_lshlrev_b32 v86, 16, v77
    v_and_b32 v87, s60, v77
    v_sub_f32 v80, v80, v84
    v_sub_f32 v81, v81, v85
    v_sub_f32 v82, v82, v86
    v_sub_f32 v83, v83, v87
    v_cvt_pk_bf16_f32 v78, v80, v81
    v_cvt_pk_bf16_f32 v79, v82, v83
    s_cmp_lg_u32 s4, 0
    s_cbranch_scc1 L_KQ_h
    s_waitcnt lgkmcnt(0)
    v_readfirstlane_b32 s55, v15
    s_nop 0
    s_cmp_ge_u32 s55, 3
    s_nop 1
    s_cbranch_scc1 L_KQ_kv
L_w_53:
    ds_read_b32 v14, v4 offset:12
    s_waitcnt lgkmcnt(0)
    v_readfirstlane_b32 s55, v14
    s_nop 0
    s_cmp_ge_u32 s55, 3
    s_nop 1
    s_cbranch_scc1 L_wd_54
    s_sleep 1
    s_add_u32 s66, s66, 1
    s_cmp_lt_u32 s66, 200000
    s_cbranch_scc1 L_w_53
L_wd_54:
L_KQ_kv:
    s_call_b64 s[6:7], L_B8
L_KQ_h:
    v_mfma_f32_16x16x32_bf16 v[172:175], v[76:79], v[104:107], 0
    v_mfma_f32_16x16x32_bf16 v[176:179], v[76:79], v[108:111], 0
    v_mfma_f32_16x16x32_bf16 v[180:183], v[76:79], v[112:115], 0
    v_mfma_f32_16x16x32_bf16 v[184:187], v[76:79], v[116:119], 0
    v_mfma_f32_16x16x32_bf16 v[188:191], v[76:79], v[120:123], 0
    v_mfma_f32_16x16x32_bf16 v[192:195], v[76:79], v[124:127], 0
    v_mfma_f32_16x16x32_bf16 v[196:199], v[76:79], v[128:131], 0
    v_mfma_f32_16x16x32_bf16 v[200:203], v[76:79], v[132:135], 0
    s_cmp_lg_u32 s4, 2
    s_nop 5
    s_cbranch_scc1 L_KQ_all
    v_cvt_pk_bf16_f32 v204, v172, v176
    v_cvt_pk_bf16_f32 v205, v180, v184
    v_cvt_pk_bf16_f32 v206, v173, v177
    v_cvt_pk_bf16_f32 v207, v181, v185
    v_cvt_pk_bf16_f32 v208, v174, v178
    v_cvt_pk_bf16_f32 v209, v182, v186
    v_cvt_pk_bf16_f32 v210, v175, v179
    v_cvt_pk_bf16_f32 v211, v183, v187
    v_mfma_f32_16x16x32_bf16 v[172:175], v[76:79], v[136:139], 0
    v_mfma_f32_16x16x32_bf16 v[176:179], v[76:79], v[140:143], 0
    v_mfma_f32_16x16x32_bf16 v[180:183], v[76:79], v[144:147], 0
    v_mfma_f32_16x16x32_bf16 v[184:187], v[76:79], v[148:151], 0
    buffer_store_dwordx2 v[204:205], v3, s[36:39], s61 offen offset:0 nt
    buffer_store_dwordx2 v[206:207], v3, s[36:39], s61 offen offset:384 nt
    buffer_store_dwordx2 v[208:209], v3, s[36:39], s61 offen offset:768 nt
    buffer_store_dwordx2 v[210:211], v3, s[36:39], s61 offen offset:1152 nt
    v_cvt_pk_bf16_f32 v212, v188, v192
    v_cvt_pk_bf16_f32 v213, v196, v200
    v_cvt_pk_bf16_f32 v214, v189, v193
    v_cvt_pk_bf16_f32 v215, v197, v201
    v_cvt_pk_bf16_f32 v216, v190, v194
    v_cvt_pk_bf16_f32 v217, v198, v202
    v_cvt_pk_bf16_f32 v218, v191, v195
    v_cvt_pk_bf16_f32 v219, v199, v203
    buffer_store_dwordx2 v[212:213], v3, s[36:39], s61 offen offset:128 nt
    buffer_store_dwordx2 v[214:215], v3, s[36:39], s61 offen offset:512 nt
    buffer_store_dwordx2 v[216:217], v3, s[36:39], s61 offen offset:896 nt
    buffer_store_dwordx2 v[218:219], v3, s[36:39], s61 offen offset:1280 nt
    v_cvt_pk_bf16_f32 v220, v172, v176
    v_cvt_pk_bf16_f32 v221, v180, v184
    v_cvt_pk_bf16_f32 v222, v173, v177
    v_cvt_pk_bf16_f32 v223, v181, v185
    v_cvt_pk_bf16_f32 v224, v174, v178
    v_cvt_pk_bf16_f32 v225, v182, v186
    v_cvt_pk_bf16_f32 v226, v175, v179
    v_cvt_pk_bf16_f32 v227, v183, v187
    buffer_store_dwordx2 v[220:221], v3, s[36:39], s61 offen offset:256 nt
    buffer_store_dwordx2 v[222:223], v3, s[36:39], s61 offen offset:640 nt
    buffer_store_dwordx2 v[224:225], v3, s[36:39], s61 offen offset:1024 nt
    buffer_store_dwordx2 v[226:227], v3, s[36:39], s61 offen offset:1408 nt
    s_branch L_fin
L_KQ_all:
L_w_55:
    ds_read_b32 v14, v4 offset:48
    s_waitcnt lgkmcnt(0)
    v_readfirstlane_b32 s55, v14
    s_nop 0
    s_cmp_ge_u32 s55, 268
    s_nop 1
    s_cbranch_scc1 L_wd_56
    s_sleep 1
    s_add_u32 s66, s66, 1
    s_cmp_lt_u32 s66, 200000
    s_cbranch_scc1 L_w_55
L_wd_56:
    s_sub_u32 s52, s61, 24576
    buffer_store_dwordx2 v[232:233], v3, s[36:39], s52 offen offset:0 nt
    buffer_store_dwordx2 v[234:235], v3, s[36:39], s52 offen offset:384 nt
    buffer_store_dwordx2 v[236:237], v3, s[36:39], s52 offen offset:768 nt
    buffer_store_dwordx2 v[238:239], v3, s[36:39], s52 offen offset:1152 nt
    v_cvt_pk_bf16_f32 v204, v172, v176
    v_cvt_pk_bf16_f32 v205, v180, v184
    v_cvt_pk_bf16_f32 v206, v173, v177
    v_cvt_pk_bf16_f32 v207, v181, v185
    v_cvt_pk_bf16_f32 v208, v174, v178
    v_cvt_pk_bf16_f32 v209, v182, v186
    v_cvt_pk_bf16_f32 v210, v175, v179
    v_cvt_pk_bf16_f32 v211, v183, v187
    v_mfma_f32_16x16x32_bf16 v[172:175], v[76:79], v[136:139], 0
    v_mfma_f32_16x16x32_bf16 v[176:179], v[76:79], v[140:143], 0
    v_mfma_f32_16x16x32_bf16 v[180:183], v[76:79], v[144:147], 0
    v_mfma_f32_16x16x32_bf16 v[184:187], v[76:79], v[148:151], 0
    buffer_store_dwordx2 v[240:241], v3, s[36:39], s52 offen offset:128 nt
    buffer_store_dwordx2 v[242:243], v3, s[36:39], s52 offen offset:512 nt
    buffer_store_dwordx2 v[244:245], v3, s[36:39], s52 offen offset:896 nt
    buffer_store_dwordx2 v[246:247], v3, s[36:39], s52 offen offset:1280 nt
    v_cvt_pk_bf16_f32 v212, v188, v192
    v_cvt_pk_bf16_f32 v213, v196, v200
    v_cvt_pk_bf16_f32 v214, v189, v193
    v_cvt_pk_bf16_f32 v215, v197, v201
    v_cvt_pk_bf16_f32 v216, v190, v194
    v_cvt_pk_bf16_f32 v217, v198, v202
    v_cvt_pk_bf16_f32 v218, v191, v195
    v_cvt_pk_bf16_f32 v219, v199, v203
    buffer_store_dwordx2 v[248:249], v3, s[36:39], s52 offen offset:256 nt
    buffer_store_dwordx2 v[250:251], v3, s[36:39], s52 offen offset:640 nt
    buffer_store_dwordx2 v[252:253], v3, s[36:39], s52 offen offset:1024 nt
    buffer_store_dwordx2 v[254:255], v3, s[36:39], s52 offen offset:1408 nt
    v_cvt_pk_bf16_f32 v220, v172, v176
    v_cvt_pk_bf16_f32 v221, v180, v184
    v_cvt_pk_bf16_f32 v222, v173, v177
    v_cvt_pk_bf16_f32 v223, v181, v185
    v_cvt_pk_bf16_f32 v224, v174, v178
    v_cvt_pk_bf16_f32 v225, v182, v186
    v_cvt_pk_bf16_f32 v226, v175, v179
    v_cvt_pk_bf16_f32 v227, v183, v187
    buffer_store_dwordx2 v[204:205], v3, s[36:39], s61 offen offset:0 nt
    buffer_store_dwordx2 v[206:207], v3, s[36:39], s61 offen offset:384 nt
    buffer_store_dwordx2 v[208:209], v3, s[36:39], s61 offen offset:768 nt
    buffer_store_dwordx2 v[210:211], v3, s[36:39], s61 offen offset:1152 nt
    buffer_store_dwordx2 v[212:213], v3, s[36:39], s61 offen offset:128 nt
    buffer_store_dwordx2 v[214:215], v3, s[36:39], s61 offen offset:512 nt
    buffer_store_dwordx2 v[216:217], v3, s[36:39], s61 offen offset:896 nt
    buffer_store_dwordx2 v[218:219], v3, s[36:39], s61 offen offset:1280 nt
    buffer_store_dwordx2 v[220:221], v3, s[36:39], s61 offen offset:256 nt
    buffer_store_dwordx2 v[222:223], v3, s[36:39], s61 offen offset:640 nt
    buffer_store_dwordx2 v[224:225], v3, s[36:39], s61 offen offset:1024 nt
    buffer_store_dwordx2 v[226:227], v3, s[36:39], s61 offen offset:1408 nt
    s_branch L_fin
L_B8:
    ds_read2st64_b64 v[104:107], v228 offset0:0 offset1:0
    ds_read2st64_b64 v[108:111], v229 offset0:0 offset1:0
    ds_read2st64_b64 v[112:115], v228 offset0:2 offset1:2
    ds_read2st64_b64 v[116:119], v229 offset0:2 offset1:2
    ds_read2st64_b64 v[120:123], v228 offset0:4 offset1:4
    ds_read2st64_b64 v[124:127], v229 offset0:4 offset1:4
    ds_read2st64_b64 v[128:131], v228 offset0:6 offset1:6
    ds_read2st64_b64 v[132:135], v229 offset0:6 offset1:6
    ds_read2st64_b64 v[136:139], v228 offset0:8 offset1:8
    ds_read2st64_b64 v[140:143], v229 offset0:8 offset1:8
    ds_read2st64_b64 v[144:147], v228 offset0:10 offset1:10
    ds_read2st64_b64 v[148:151], v229 offset0:10 offset1:10
    s_mov_b32 s4, 1
    s_waitcnt lgkmcnt(8)
    v_mfma_f32_16x16x32_bf16 v[172:175], v[152:155], v[104:107], 0
    v_mfma_f32_16x16x32_bf16 v[176:179], v[152:155], v[108:111], 0
    v_mfma_f32_16x16x32_bf16 v[180:183], v[152:155], v[112:115], 0
    v_mfma_f32_16x16x32_bf16 v[184:187], v[152:155], v[116:119], 0
    s_waitcnt lgkmcnt(4)
    v_mfma_f32_16x16x32_bf16 v[188:191], v[152:155], v[120:123], 0
    v_mfma_f32_16x16x32_bf16 v[192:195], v[152:155], v[124:127], 0
    v_mfma_f32_16x16x32_bf16 v[196:199], v[152:155], v[128:131], 0
    v_mfma_f32_16x16x32_bf16 v[200:203], v[152:155], v[132:135], 0
    s_nop 0
    v_cvt_pk_bf16_f32 v232, v172, v176
    s_nop 0
    v_cvt_pk_bf16_f32 v233, v180, v184
    v_cvt_pk_bf16_f32 v234, v173, v177
    v_cvt_pk_bf16_f32 v235, v181, v185
    v_cvt_pk_bf16_f32 v236, v174, v178
    v_cvt_pk_bf16_f32 v237, v182, v186
    v_cvt_pk_bf16_f32 v238, v175, v179
    v_cvt_pk_bf16_f32 v239, v183, v187
    s_waitcnt lgkmcnt(0)
    v_mfma_f32_16x16x32_bf16 v[172:175], v[152:155], v[136:139], 0
    v_mfma_f32_16x16x32_bf16 v[176:179], v[152:155], v[140:143], 0
    v_mfma_f32_16x16x32_bf16 v[180:183], v[152:155], v[144:147], 0
    v_mfma_f32_16x16x32_bf16 v[184:187], v[152:155], v[148:151], 0
    v_cvt_pk_bf16_f32 v240, v188, v192
    v_cvt_pk_bf16_f32 v241, v196, v200
    v_cvt_pk_bf16_f32 v242, v189, v193
    v_cvt_pk_bf16_f32 v243, v197, v201
    v_cvt_pk_bf16_f32 v244, v190, v194
    v_cvt_pk_bf16_f32 v245, v198, v202
    v_cvt_pk_bf16_f32 v246, v191, v195
    v_cvt_pk_bf16_f32 v247, v199, v203
    v_cvt_pk_bf16_f32 v248, v172, v176
    v_cvt_pk_bf16_f32 v249, v180, v184
    v_cvt_pk_bf16_f32 v250, v173, v177
    v_cvt_pk_bf16_f32 v251, v181, v185
    v_cvt_pk_bf16_f32 v252, v174, v178
    v_cvt_pk_bf16_f32 v253, v182, v186
    v_cvt_pk_bf16_f32 v254, v175, v179
    v_cvt_pk_bf16_f32 v255, v183, v187
    s_nop 0
    s_setpc_b64 s[6:7]
L_PHI:
    ds_read_b128 v[48:51], v8
    ds_read_b128 v[52:55], v9
    ds_read_b128 v[56:59], v10
    ds_read_b128 v[60:63], v11
    ds_read_b128 v[64:67], v12
    ds_read_b128 v[68:71], v13
    v_add_u32 v8, s63, v8
    v_add_u32 v9, s63, v9
    v_add_u32 v10, s63, v10
    v_add_u32 v11, s63, v11
    v_add_u32 v12, s63, v12
    v_add_u32 v13, s63, v13
    s_waitcnt lgkmcnt(5)
    v_lshlrev_b32 v84, 16, v48
    v_and_b32 v85, s60, v48
    v_lshlrev_b32 v86, 16, v49
    v_and_b32 v87, s60, v49
    v_lshlrev_b32 v88, 16, v50
    v_and_b32 v89, s60, v50
    v_lshlrev_b32 v90, 16, v51
    v_and_b32 v91, s60, v51
    v_pk_mul_f32 v[84:85], v[84:85], s[56:57]
    v_pk_mul_f32 v[86:87], v[86:87], s[56:57]
    v_pk_mul_f32 v[88:89], v[88:89], s[56:57]
    v_pk_mul_f32 v[90:91], v[90:91], s[56:57]
    v_cvt_pk_bf16_f32 v48, v84, v85
    v_cvt_pk_bf16_f32 v49, v86, v87
    v_cvt_pk_bf16_f32 v50, v88, v89
    v_cvt_pk_bf16_f32 v51, v90, v91
    s_waitcnt lgkmcnt(4)
    v_lshlrev_b32 v84, 16, v52
    v_and_b32 v85, s60, v52
    v_lshlrev_b32 v86, 16, v53
    v_and_b32 v87, s60, v53
    v_lshlrev_b32 v88, 16, v54
    v_and_b32 v89, s60, v54
    v_lshlrev_b32 v90, 16, v55
    v_and_b32 v91, s60, v55
    v_pk_mul_f32 v[84:85], v[84:85], s[56:57]
    v_pk_mul_f32 v[86:87], v[86:87], s[56:57]
    v_pk_mul_f32 v[88:89], v[88:89], s[56:57]
    v_pk_mul_f32 v[90:91], v[90:91], s[56:57]
    v_cvt_pk_bf16_f32 v52, v84, v85
    v_cvt_pk_bf16_f32 v53, v86, v87
    v_cvt_pk_bf16_f32 v54, v88, v89
    v_cvt_pk_bf16_f32 v55, v90, v91
    v_mfma_f32_16x16x32_bf16 v[72:75], v[24:27], v[48:51], 0
    v_mfma_f32_16x16x32_bf16 v[76:79], v[48:51], v[48:51], 0
    s_waitcnt lgkmcnt(3)
    v_lshlrev_b32 v84, 16, v56
    v_and_b32 v85, s60, v56
    v_lshlrev_b32 v86, 16, v57
    v_and_b32 v87, s60, v57
    v_lshlrev_b32 v88, 16, v58
    v_and_b32 v89, s60, v58
    v_lshlrev_b32 v90, 16, v59
    v_and_b32 v91, s60, v59
    v_pk_mul_f32 v[84:85], v[84:85], s[56:57]
    v_pk_mul_f32 v[86:87], v[86:87], s[56:57]
    v_pk_mul_f32 v[88:89], v[88:89], s[56:57]
    v_pk_mul_f32 v[90:91], v[90:91], s[56:57]
    v_cvt_pk_bf16_f32 v56, v84, v85
    v_cvt_pk_bf16_f32 v57, v86, v87
    v_cvt_pk_bf16_f32 v58, v88, v89
    v_cvt_pk_bf16_f32 v59, v90, v91
    v_mfma_f32_16x16x32_bf16 v[72:75], v[28:31], v[52:55], v[72:75]
    v_mfma_f32_16x16x32_bf16 v[76:79], v[52:55], v[52:55], v[76:79]
    s_waitcnt lgkmcnt(2)
    v_lshlrev_b32 v84, 16, v60
    v_and_b32 v85, s60, v60
    v_lshlrev_b32 v86, 16, v61
    v_and_b32 v87, s60, v61
    v_lshlrev_b32 v88, 16, v62
    v_and_b32 v89, s60, v62
    v_lshlrev_b32 v90, 16, v63
    v_and_b32 v91, s60, v63
    v_pk_mul_f32 v[84:85], v[84:85], s[56:57]
    v_pk_mul_f32 v[86:87], v[86:87], s[56:57]
    v_pk_mul_f32 v[88:89], v[88:89], s[56:57]
    v_pk_mul_f32 v[90:91], v[90:91], s[56:57]
    v_cvt_pk_bf16_f32 v60, v84, v85
    v_cvt_pk_bf16_f32 v61, v86, v87
    v_cvt_pk_bf16_f32 v62, v88, v89
    v_cvt_pk_bf16_f32 v63, v90, v91
    v_mfma_f32_16x16x32_bf16 v[72:75], v[32:35], v[56:59], v[72:75]
    v_mfma_f32_16x16x32_bf16 v[76:79], v[56:59], v[56:59], v[76:79]
    s_waitcnt lgkmcnt(1)
    v_lshlrev_b32 v84, 16, v64
    v_and_b32 v85, s60, v64
    v_lshlrev_b32 v86, 16, v65
    v_and_b32 v87, s60, v65
    v_lshlrev_b32 v88, 16, v66
    v_and_b32 v89, s60, v66
    v_lshlrev_b32 v90, 16, v67
    v_and_b32 v91, s60, v67
    v_pk_mul_f32 v[84:85], v[84:85], s[56:57]
    v_pk_mul_f32 v[86:87], v[86:87], s[56:57]
    v_pk_mul_f32 v[88:89], v[88:89], s[56:57]
    v_pk_mul_f32 v[90:91], v[90:91], s[56:57]
    v_cvt_pk_bf16_f32 v64, v84, v85
    v_cvt_pk_bf16_f32 v65, v86, v87
    v_cvt_pk_bf16_f32 v66, v88, v89
    v_cvt_pk_bf16_f32 v67, v90, v91
    v_mfma_f32_16x16x32_bf16 v[72:75], v[36:39], v[60:63], v[72:75]
    v_mfma_f32_16x16x32_bf16 v[76:79], v[60:63], v[60:63], v[76:79]
    s_waitcnt lgkmcnt(0)
    v_lshlrev_b32 v84, 16, v68
    v_and_b32 v85, s60, v68
    v_lshlrev_b32 v86, 16, v69
    v_and_b32 v87, s60, v69
    v_lshlrev_b32 v88, 16, v70
    v_and_b32 v89, s60, v70
    v_lshlrev_b32 v90, 16, v71
    v_and_b32 v91, s60, v71
    v_pk_mul_f32 v[84:85], v[84:85], s[56:57]
    v_pk_mul_f32 v[86:87], v[86:87], s[56:57]
    v_pk_mul_f32 v[88:89], v[88:89], s[56:57]
    v_pk_mul_f32 v[90:91], v[90:91], s[56:57]
    v_cvt_pk_bf16_f32 v68, v84, v85
    v_cvt_pk_bf16_f32 v69, v86, v87
    v_cvt_pk_bf16_f32 v70, v88, v89
    v_cvt_pk_bf16_f32 v71, v90, v91
    v_mfma_f32_16x16x32_bf16 v[72:75], v[40:43], v[64:67], v[72:75]
    v_mfma_f32_16x16x32_bf16 v[76:79], v[64:67], v[64:67], v[76:79]
    v_mfma_f32_16x16x32_bf16 v[72:75], v[44:47], v[68:71], v[72:75]
    v_mfma_f32_16x16x32_bf16 v[76:79], v[68:71], v[68:71], v[76:79]
    s_nop 6
    v_cvt_pk_bf16_f32 v20, v72, v73
    v_cvt_pk_bf16_f32 v21, v74, v75
    v_cvt_pk_bf16_f32 v22, v76, v77
    v_cvt_pk_bf16_f32 v23, v78, v79
    v_and_b32 v22, v6, v22
    v_and_b32 v23, v7, v23
    s_nop 1
    v_mfma_f32_16x16x32_bf16 v[80:83], v[16:19], v[20:23], 0
    s_nop 7
    v_cvt_pk_bf16_f32 v84, v80, v81
    v_cvt_pk_bf16_f32 v85, v82, v83
    v_lshlrev_b32 v80, 16, v84
    v_and_b32 v81, s60, v84
    v_lshlrev_b32 v82, 16, v85
    v_and_b32 v83, s60, v85
    v_pk_mul_f32 v[80:81], v[80:81], s[58:59]
    v_pk_mul_f32 v[82:83], v[82:83], s[58:59]
    v_exp_f32 v80, v80
    v_exp_f32 v81, v81
    v_exp_f32 v82, v82
    v_exp_f32 v83, v83
    v_cvt_pk_bf16_f32 v84, v80, v81
    v_cvt_pk_bf16_f32 v85, v82, v83
    v_lshlrev_b32 v80, 16, v84
    v_and_b32 v81, s60, v84
    v_lshlrev_b32 v82, 16, v85
    v_and_b32 v83, s60, v85
    v_pk_fma_f32 v[80:81], v[80:81], s[64:65], v[100:101]
    v_pk_fma_f32 v[82:83], v[82:83], s[64:65], v[100:101]
    v_cvt_pk_bf16_f32 v92, v80, v81
    v_cvt_pk_bf16_f32 v93, v82, v83
    s_nop 0
    s_setpc_b64 s[68:69]
L_V:
    s_sub_u32 s3, s48, 5
    v_lshrrev_b32 v72, 2, v1
    v_bfe_u32 v73, v1, 1, 1
    v_and_b32 v74, 7, v72
    v_xor_b32 v73, v73, v74
    v_lshlrev_b32 v73, 4, v73
    v_lshl_add_u32 v73, v72, 7, v73
    v_and_b32 v74, 1, v1
    v_lshl_add_u32 v73, v74, 3, v73
    s_lshl_b32 s52, s3, 15
    s_cmp_eq_u32 s3, 2
    s_cselect_b32 s52, 98304, s52
    v_add_u32 v88, s52, v73
    v_xor_b32 v89, 32, v88
    v_xor_b32 v90, 64, v88
    v_xor_b32 v91, 96, v88
    v_lshrrev_b32 v80, 3, v1
    v_and_b32 v81, 7, v1
    v_lshlrev_b32 v81, 4, v81
    v_lshrrev_b32 v72, 5, v1
    v_lshlrev_b32 v82, 4, v14
    v_lshl_add_u32 v82, v15, 9, v82
    v_and_b32 v83, 15, v1
    v_lshlrev_b32 v83, 4, v83
    v_mul_u32_u24 v73, 104448, v15
    v_add_u32 v83, v83, v73
    v_bfe_u32 v84, v1, 2, 4
    v_lshlrev_b32 v84, 4, v84
    v_lshl_add_u32 v84, v74, 3, v84
    v_bfe_u32 v72, v1, 1, 1
    v_lshl_add_u32 v84, v72, 10, v84
    v_add_u32 v86, 147456, v5
    v_add_u32 v87, 8, v86
    s_waitcnt lgkmcnt(0)
    s_mov_b32 s44, s16
    s_and_b32 s45, s17, 0xffff
    s_mov_b32 s46, 268435456
    s_mov_b32 s47, 0x20000
    s_mov_b32 s36, s12
    s_and_b32 s37, s13, 0xffff
    s_mov_b32 s38, 25165824
    s_mov_b32 s39, 0x20000
    s_lshl_b32 s52, s50, 3
    s_add_u32 s52, s52, s51
    s_mul_i32 s62, s51, 6144
    s_add_u32 s62, s62, s49
    s_add_u32 s62, s62, 49152
    s_cmp_lg_u32 s3, 2
    s_cbranch_scc1 L_Vgo
    s_mov_b32 s40, s14
    s_and_b32 s41, s15, 0xffff
    s_mov_b32 s42, 256
    s_mov_b32 s43, 0x20000
    v_mov_b32 v72, -1
    v_mov_b32 v73, -1
    v_mov_b32 v74, -1
    v_mov_b32 v75, -1
    v_bfrev_b32 v24, 1
    v_bfrev_b32 v25, 1
    v_bfrev_b32 v26, 1
    v_bfrev_b32 v27, 1
    s_lshl_b32 s18, s50, 13
    s_lshl_b32 s67, s51, 7
    s_add_u32 s18, s18, s67
    v_lshl_add_u32 v76, v80, 10, v81
    v_lshlrev_b32 v77, 7, v1
    s_mov_b32 exec_lo, 0
    s_mov_b32 exec_hi, 0xff0000
    buffer_store_dwordx4 v[72:75], v76, s[44:47], s18 offen sc1
    s_mov_b64 exec, -1
    s_add_u32 s67, s62, 0
    buffer_store_dwordx4 v[24:27], v5, s[36:39], s67 offen offset:0
    buffer_store_dwordx4 v[24:27], v5, s[36:39], s67 offen offset:1024
    buffer_store_dwordx4 v[24:27], v5, s[36:39], s67 offen offset:2048
    buffer_store_dwordx4 v[24:27], v5, s[36:39], s67 offen offset:3072
    s_add_u32 s67, s62, 4096
    buffer_store_dwordx4 v[24:27], v5, s[36:39], s67 offen offset:0
    buffer_store_dwordx4 v[24:27], v5, s[36:39], s67 offen offset:1024
    s_mov_b32 exec_lo, -1
    s_mov_b32 exec_hi, 65535
    buffer_store_dwordx4 v[72:75], v76, s[44:47], s18 offen
    s_mov_b64 exec, -1
    s_mov_b32 exec_hi, 0xffff
    buffer_load_dword v184, v77, s[36:39], s62 offen nt
    s_mov_b32 exec_lo, 0x01010101
    s_mov_b32 exec_hi, 0x0101
    buffer_load_dword v186, v76, s[44:47], s18 offen nt
    s_mov_b64 exec, -1
    s_getreg_b32 s52, hwreg(HW_REG_XCC_ID, 0, 4)
    s_or_b32 s52, s52, 0x80
    v_mov_b32 v80, s52
    s_mul_i32 s63, s52, 0x01010101
    v_mov_b32 v15, 0
    s_lshl_b32 s8, s50, 3
    s_add_u32 s53, s8, s51
    s_mov_b32 s61, 0
    s_waitcnt vmcnt(0)
    s_mov_b64 exec, 1
    buffer_store_byte v80, v15, s[40:43], s53 offen
L_Z_poll:
    buffer_load_dwordx2 v[80:81], v15, s[40:43], s8 offen sc1
    s_waitcnt vmcnt(0)
    v_readfirstlane_b32 s54, v80
    v_readfirstlane_b32 s55, v81
    s_xor_b32 s54, s54, s63
    s_xor_b32 s55, s55, s63
    s_or_b32 s54, s54, s55
    s_mov_b32 s52, 2
    s_cbranch_scc0 L_Z_clr
    s_sleep 2
    s_add_u32 s61, s61, 1
    s_cmp_lt_u32 s61, 8
    s_cbranch_scc1 L_Z_poll
    s_mov_b64 exec, -1
    s_add_u32 s67, s62, 0
    buffer_store_dwordx4 v[24:27], v5, s[36:39], s67 offen offset:0 sc1
    buffer_store_dwordx4 v[24:27], v5, s[36:39], s67 offen offset:1024 sc1
    buffer_store_dwordx4 v[24:27], v5, s[36:39], s67 offen offset:2048 sc1
    buffer_store_dwordx4 v[24:27], v5, s[36:39], s67 offen offset:3072 sc1
    s_add_u32 s67, s62, 4096
    buffer_store_dwordx4 v[24:27], v5, s[36:39], s67 offen offset:0 sc1
    buffer_store_dwordx4 v[24:27], v5, s[36:39], s67 offen offset:1024 sc1
    s_mov_b32 exec_lo, -1
    s_mov_b32 exec_hi, 65535
    buffer_store_dwordx4 v[72:75], v76, s[44:47], s18 offen sc1
    s_mov_b64 exec, -1
    v_lshlrev_b32 v76, 2, v1
    s_lshl_b32 s53, s50, 13
    s_lshl_b32 s61, s51, 2
    s_add_u32 s53, s53, s61
    s_add_u32 s53, s53, 6208
    s_add_u32 s61, s18, 6208
    s_waitcnt vmcnt(0)
    s_mov_b64 exec, 0xff
L_Z_poll2:
    buffer_store_dword v15, v77, s[44:47], s53 offen sc1
    buffer_load_dwordx2 v[80:81], v15, s[40:43], s8 offen sc1
    buffer_load_dword v72, v76, s[44:47], s61 offen sc1
    s_waitcnt vmcnt(0)
    v_readfirstlane_b32 s54, v80
    v_readfirstlane_b32 s55, v81
    s_xor_b32 s54, s54, s63
    s_xor_b32 s55, s55, s63
    s_or_b32 s54, s54, s55
    s_mov_b32 s52, 2
    s_cbranch_scc0 L_Z_clr
    v_cmp_ne_u32 vcc, 0, v72
    s_nop 0
    s_cmp_eq_u64 vcc, 0
    s_nop 1
    s_cbranch_scc1 L_Z_rdy
    s_sleep 8
    s_add_u32 s66, s66, 1
    s_cmp_lt_u32 s66, 200000
    s_cbranch_scc1 L_Z_poll2
L_Z_rdy:
    buffer_store_dword v15, v77, s[44:47], s53 offen sc1
    s_mov_b32 s52, 3
L_Z_clr:
    v_mov_b32 v14, s52
    ds_write_b32 v4, v14 offset:8
    s_mov_b64 exec, -1
L_Vgo:
    s_mul_i32 s53, s3, 2048
    s_add_u32 s6, s62, s53
    s_mul_i32 s53, s51, 104192
    s_sub_u32 s9, s6, s53
    s_add_u32 s10, s9, 417792
    s_add_u32 s11, s9, 835584
    s_add_u32 s12, s9, 1253376
    s_lshl_b32 s13, s50, 13
    s_lshl_b32 s53, s3, 11
    s_add_u32 s13, s13, s53
    s_lshr_b32 s53, s51, 1
    s_lshl_b32 s53, s53, 8
    s_add_u32 s14, s13, s53
    s_and_b32 s53, s51, 1
    s_lshl_b32 s53, s53, 2
    s_add_u32 s14, s14, s53
    v_mov_b32 v16, 0x7e7fc000
    v_mov_b32 v17, 0x00020002
    v_mov_b32 v18, 0xf9000000
    s_mov_b32 s24, 0x30003
    s_mov_b32 s25, 0xff800000
    s_mov_b32 s26, 0xfb
    s_mov_b32 s27, 0x800200
    s_mov_b32 s28, 0x7f800000
    s_mov_b32 s30, 0x3f802108
    s_mov_b32 s31, 0x3f802108
    s_lshl_b32 s61, s3, 7
    s_add_u32 s61, s61, s49
    s_lshl_b32 s18, s3, 5
    v_add_u32 v15, 131072, v94
L_w_57:
    ds_read_b128 v[96:99], v4 offset:16
    s_waitcnt lgkmcnt(0)
    v_min3_u32 v96, v96, v97, v98
    v_min_u32 v96, v96, v99
    s_nop 0
    v_readfirstlane_b32 s55, v96
    s_nop 0
    s_cmp_ge_u32 s55, 4
    s_nop 1
    s_cbranch_scc1 L_wd_58
    s_sleep 2
    s_add_u32 s66, s66, 1
    s_cmp_lt_u32 s66, 200000
    s_cbranch_scc1 L_w_57
L_wd_58:
    ds_read_b64_tr_b16 v[24:25], v15 offset:0
    ds_read_b64_tr_b16 v[26:27], v15 offset:512
    ds_read_b64_tr_b16 v[28:29], v15 offset:1024
    ds_read_b64_tr_b16 v[30:31], v15 offset:1536
    ds_read_b64_tr_b16 v[32:33], v15 offset:2048
    ds_read_b64_tr_b16 v[34:35], v15 offset:2560
    ds_read_b64_tr_b16 v[36:37], v15 offset:3072
    ds_read_b64_tr_b16 v[38:39], v15 offset:3584
    ds_read_b64_tr_b16 v[40:41], v15 offset:4096
    ds_read_b64_tr_b16 v[42:43], v15 offset:4608
    ds_read_b64_tr_b16 v[44:45], v15 offset:5120
    ds_read_b64_tr_b16 v[46:47], v15 offset:5632
    ds_read_b64_tr_b16 v[48:49], v15 offset:6144
    ds_read_b64_tr_b16 v[50:51], v15 offset:6656
    ds_read_b64_tr_b16 v[52:53], v15 offset:7168
    ds_read_b64_tr_b16 v[54:55], v15 offset:7680
    s_add_u32 s54, s18, 112
L_w_59:
    ds_read_b32 v14, v4 offset:48
    s_waitcnt lgkmcnt(0)
    v_readfirstlane_b32 s55, v14
    s_nop 0
    s_cmp_ge_u32 s55, s54
    s_nop 1
    s_cbranch_scc1 L_wd_60
    s_sleep 1
    s_add_u32 s66, s66, 1
    s_cmp_lt_u32 s66, 200000
    s_cbranch_scc1 L_w_59
L_wd_60:
    ds_read_b64_tr_b16 v[104:105], v88 offset:0
    ds_read_b64_tr_b16 v[106:107], v88 offset:2048
    ds_read_b64_tr_b16 v[108:109], v89 offset:0
    ds_read_b64_tr_b16 v[110:111], v89 offset:2048
    ds_read_b64_tr_b16 v[112:113], v90 offset:0
    ds_read_b64_tr_b16 v[114:115], v90 offset:2048
    ds_read_b64_tr_b16 v[116:117], v91 offset:0
    ds_read_b64_tr_b16 v[118:119], v91 offset:2048
    ds_read_b64_tr_b16 v[120:121], v88 offset:4096
    ds_read_b64_tr_b16 v[122:123], v88 offset:6144
    ds_read_b64_tr_b16 v[124:125], v89 offset:4096
    ds_read_b64_tr_b16 v[126:127], v89 offset:6144
    ds_read_b64_tr_b16 v[128:129], v90 offset:4096
    ds_read_b64_tr_b16 v[130:131], v90 offset:6144
    ds_read_b64_tr_b16 v[132:133], v91 offset:4096
    ds_read_b64_tr_b16 v[134:135], v91 offset:6144
    s_waitcnt lgkmcnt(14)
    v_mfma_f32_16x16x32_bf16 v[56:59], v[24:27], v[104:107], 0
    s_waitcnt lgkmcnt(12)
    v_mfma_f32_16x16x32_bf16 v[60:63], v[24:27], v[108:111], 0
    s_waitcnt lgkmcnt(10)
    v_mfma_f32_16x16x32_bf16 v[64:67], v[24:27], v[112:115], 0
    s_waitcnt lgkmcnt(8)
    v_mfma_f32_16x16x32_bf16 v[68:71], v[24:27], v[116:119], 0
    ds_read_b64_tr_b16 v[104:105], v88 offset:8192
    ds_read_b64_tr_b16 v[106:107], v88 offset:10240
    ds_read_b64_tr_b16 v[108:109], v89 offset:8192
    ds_read_b64_tr_b16 v[110:111], v89 offset:10240
    ds_read_b64_tr_b16 v[112:113], v90 offset:8192
    ds_read_b64_tr_b16 v[114:115], v90 offset:10240
    ds_read_b64_tr_b16 v[116:117], v91 offset:8192
    ds_read_b64_tr_b16 v[118:119], v91 offset:10240
    s_waitcnt lgkmcnt(14)
    v_mfma_f32_16x16x32_bf16 v[56:59], v[28:31], v[120:123], v[56:59]
    s_waitcnt lgkmcnt(12)
    v_mfma_f32_16x16x32_bf16 v[60:63], v[28:31], v[124:127], v[60:63]
    s_waitcnt lgkmcnt(10)
    v_mfma_f32_16x16x32_bf16 v[64:67], v[28:31], v[128:131], v[64:67]
    s_waitcnt lgkmcnt(8)
    v_mfma_f32_16x16x32_bf16 v[68:71], v[28:31], v[132:135], v[68:71]
    ds_read_b64_tr_b16 v[120:121], v88 offset:12288
    ds_read_b64_tr_b16 v[122:123], v88 offset:14336
    ds_read_b64_tr_b16 v[124:125], v89 offset:12288
    ds_read_b64_tr_b16 v[126:127], v89 offset:14336
    ds_read_b64_tr_b16 v[128:129], v90 offset:12288
    ds_read_b64_tr_b16 v[130:131], v90 offset:14336
    ds_read_b64_tr_b16 v[132:133], v91 offset:12288
    ds_read_b64_tr_b16 v[134:135], v91 offset:14336
    s_waitcnt lgkmcnt(14)
    v_mfma_f32_16x16x32_bf16 v[56:59], v[32:35], v[104:107], v[56:59]
    s_waitcnt lgkmcnt(12)
    v_mfma_f32_16x16x32_bf16 v[60:63], v[32:35], v[108:111], v[60:63]
    s_waitcnt lgkmcnt(10)
    v_mfma_f32_16x16x32_bf16 v[64:67], v[32:35], v[112:115], v[64:67]
    s_waitcnt lgkmcnt(8)
    v_mfma_f32_16x16x32_bf16 v[68:71], v[32:35], v[116:119], v[68:71]
    s_waitcnt lgkmcnt(6)
    v_mfma_f32_16x16x32_bf16 v[56:59], v[36:39], v[120:123], v[56:59]
    s_waitcnt lgkmcnt(4)
    v_mfma_f32_16x16x32_bf16 v[60:63], v[36:39], v[124:127], v[60:63]
    s_waitcnt lgkmcnt(2)
    v_mfma_f32_16x16x32_bf16 v[64:67], v[36:39], v[128:131], v[64:67]
    s_waitcnt lgkmcnt(0)
    v_mfma_f32_16x16x32_bf16 v[68:71], v[36:39], v[132:135], v[68:71]
    s_add_u32 s54, s18, 120
L_w_61:
    ds_read_b32 v14, v4 offset:48
    s_waitcnt lgkmcnt(0)
    v_readfirstlane_b32 s55, v14
    s_nop 0
    s_cmp_ge_u32 s55, s54
    s_nop 1
    s_cbranch_scc1 L_wd_62
    s_sleep 1
    s_add_u32 s66, s66, 1
    s_cmp_lt_u32 s66, 200000
    s_cbranch_scc1 L_w_61
L_wd_62:
    ds_read_b64_tr_b16 v[104:105], v88 offset:16384
    ds_read_b64_tr_b16 v[106:107], v88 offset:18432
    ds_read_b64_tr_b16 v[108:109], v89 offset:16384
    ds_read_b64_tr_b16 v[110:111], v89 offset:18432
    ds_read_b64_tr_b16 v[112:113], v90 offset:16384
    ds_read_b64_tr_b16 v[114:115], v90 offset:18432
    ds_read_b64_tr_b16 v[116:117], v91 offset:16384
    ds_read_b64_tr_b16 v[118:119], v91 offset:18432
    ds_read_b64_tr_b16 v[120:121], v88 offset:20480
    ds_read_b64_tr_b16 v[122:123], v88 offset:22528
    ds_read_b64_tr_b16 v[124:125], v89 offset:20480
    ds_read_b64_tr_b16 v[126:127], v89 offset:22528
    ds_read_b64_tr_b16 v[128:129], v90 offset:20480
    ds_read_b64_tr_b16 v[130:131], v90 offset:22528
    ds_read_b64_tr_b16 v[132:133], v91 offset:20480
    ds_read_b64_tr_b16 v[134:135], v91 offset:22528
    s_waitcnt lgkmcnt(14)
    v_mfma_f32_16x16x32_bf16 v[56:59], v[40:43], v[104:107], v[56:59]
    s_waitcnt lgkmcnt(12)
    v_mfma_f32_16x16x32_bf16 v[60:63], v[40:43], v[108:111], v[60:63]
    s_waitcnt lgkmcnt(10)
    v_mfma_f32_16x16x32_bf16 v[64:67], v[40:43], v[112:115], v[64:67]
    s_waitcnt lgkmcnt(8)
    v_mfma_f32_16x16x32_bf16 v[68:71], v[40:43], v[116:119], v[68:71]
    s_waitcnt lgkmcnt(6)
    v_mfma_f32_16x16x32_bf16 v[56:59], v[44:47], v[120:123], v[56:59]
    s_waitcnt lgkmcnt(4)
    v_mfma_f32_16x16x32_bf16 v[60:63], v[44:47], v[124:127], v[60:63]
    s_waitcnt lgkmcnt(2)
    v_mfma_f32_16x16x32_bf16 v[64:67], v[44:47], v[128:131], v[64:67]
    s_waitcnt lgkmcnt(0)
    v_mfma_f32_16x16x32_bf16 v[68:71], v[44:47], v[132:135], v[68:71]
    s_add_u32 s54, s18, 124
L_w_63:
    ds_read_b32 v14, v4 offset:48
    s_waitcnt lgkmcnt(0)
    v_readfirstlane_b32 s55, v14
    s_nop 0
    s_cmp_ge_u32 s55, s54
    s_nop 1
    s_cbranch_scc1 L_wd_64
    s_sleep 1
    s_add_u32 s66, s66, 1
    s_cmp_lt_u32 s66, 200000
    s_cbranch_scc1 L_w_63
L_wd_64:
    ds_read_b64_tr_b16 v[104:105], v88 offset:24576
    ds_read_b64_tr_b16 v[106:107], v88 offset:26624
    ds_read_b64_tr_b16 v[108:109], v89 offset:24576
    ds_read_b64_tr_b16 v[110:111], v89 offset:26624
    ds_read_b64_tr_b16 v[112:113], v90 offset:24576
    ds_read_b64_tr_b16 v[114:115], v90 offset:26624
    ds_read_b64_tr_b16 v[116:117], v91 offset:24576
    ds_read_b64_tr_b16 v[118:119], v91 offset:26624
    s_waitcnt lgkmcnt(6)
    v_mfma_f32_16x16x32_bf16 v[56:59], v[48:51], v[104:107], v[56:59]
    s_waitcnt lgkmcnt(4)
    v_mfma_f32_16x16x32_bf16 v[60:63], v[48:51], v[108:111], v[60:63]
    s_waitcnt lgkmcnt(2)
    v_mfma_f32_16x16x32_bf16 v[64:67], v[48:51], v[112:115], v[64:67]
    s_waitcnt lgkmcnt(0)
    v_mfma_f32_16x16x32_bf16 v[68:71], v[48:51], v[116:119], v[68:71]
    s_add_u32 s54, s18, 128
    ds_read_b32 v80, v4 offset:8
L_w_65:
    ds_read_b32 v14, v4 offset:48
    s_waitcnt lgkmcnt(0)
    v_readfirstlane_b32 s55, v14
    s_nop 0
    s_cmp_ge_u32 s55, s54
    s_nop 1
    s_cbranch_scc1 L_wd_66
    s_sleep 1
    s_add_u32 s66, s66, 1
    s_cmp_lt_u32 s66, 200000
    s_cbranch_scc1 L_w_65
L_wd_66:
    v_readfirstlane_b32 s19, v80
    ds_read_b64_tr_b16 v[120:121], v88 offset:28672
    ds_read_b64_tr_b16 v[122:123], v88 offset:30720
    ds_read_b64_tr_b16 v[124:125], v89 offset:28672
    ds_read_b64_tr_b16 v[126:127], v89 offset:30720
    ds_read_b64_tr_b16 v[128:129], v90 offset:28672
    ds_read_b64_tr_b16 v[130:131], v90 offset:30720
    ds_read_b64_tr_b16 v[132:133], v91 offset:28672
    ds_read_b64_tr_b16 v[134:135], v91 offset:30720
    s_waitcnt lgkmcnt(6)
    v_mfma_f32_16x16x32_bf16 v[56:59], v[52:55], v[120:123], v[56:59]
    s_waitcnt lgkmcnt(4)
    v_mfma_f32_16x16x32_bf16 v[60:63], v[52:55], v[124:127], v[60:63]
    s_waitcnt lgkmcnt(2)
    v_mfma_f32_16x16x32_bf16 v[64:67], v[52:55], v[128:131], v[64:67]
    s_waitcnt lgkmcnt(0)
    v_mfma_f32_16x16x32_bf16 v[68:71], v[52:55], v[132:135], v[68:71]
    s_lshl_b32 s52, s3, 2
    v_add_u32 v81, s52, v4
    v_mov_b32 v14, 1
    ds_write_b32 v81, v14 offset:56
    s_cmp_ge_u32 s19, 2
    s_nop 1
    s_cbranch_scc1 L_clrok
L_w_67:
    ds_read_b32 v14, v4 offset:8
    s_waitcnt lgkmcnt(0)
    v_readfirstlane_b32 s55, v14
    s_nop 0
    s_cmp_ge_u32 s55, 2
    s_nop 1
    s_cbranch_scc1 L_wd_68
    s_sleep 2
    s_add_u32 s66, s66, 1
    s_cmp_lt_u32 s66, 200000
    s_cbranch_scc1 L_w_67
L_wd_68:
    s_mov_b32 s19, s55
L_clrok:
    v_max3_f32 v24, |v56|, |v60|, |v64|
    v_max3_f32 v25, |v57|, |v61|, |v65|
    v_max3_f32 v26, |v58|, |v62|, |v66|
    v_max3_f32 v27, |v59|, |v63|, |v67|
    v_max_f32_e64 v24, v24, |v68|
    v_max_f32_e64 v25, v25, |v69|
    v_max_f32_e64 v26, v26, |v70|
    v_max_f32_e64 v27, v27, |v71|
    v_lshrrev_b32 v24, 23, v24
    v_lshrrev_b32 v25, 23, v25
    v_lshrrev_b32 v26, 23, v26
    v_lshrrev_b32 v27, 23, v27
    v_med3_u32 v24, v24, 15, s26
    v_med3_u32 v25, v25, 15, s26
    v_med3_u32 v26, v26, 15, s26
    v_med3_u32 v27, v27, 15, s26
    v_mad_i32_i24 v28, v24, s25, v16
    v_mad_i32_i24 v29, v25, s25, v16
    v_mad_i32_i24 v30, v26, s25, v16
    v_mad_i32_i24 v31, v27, s25, v16
    v_lshl_or_b32 v32, v24, 14, v24
    v_lshl_or_b32 v33, v25, 14, v25
    v_lshl_or_b32 v34, v26, 14, v26
    v_lshl_or_b32 v35, v27, 14, v27
    v_pk_mul_f32 v[56:57], v[56:57], v[28:29]
    v_pk_mul_f32 v[60:61], v[60:61], v[28:29]
    v_pk_mul_f32 v[64:65], v[64:65], v[28:29]
    v_pk_mul_f32 v[68:69], v[68:69], v[28:29]
    v_lshrrev_b32 v24, 4, v32
    v_cvt_pknorm_i16_f32 v36, v56, v60
    v_cvt_pknorm_i16_f32 v37, v64, v68
    v_lshrrev_b32 v25, 4, v33
    v_cvt_pknorm_i16_f32 v38, v57, v61
    v_cvt_pknorm_i16_f32 v39, v65, v69
    v_bfi_b32 v36, s24, v32, v36
    v_bfi_b32 v37, s24, v24, v37
    v_bfi_b32 v38, s24, v33, v38
    v_bfi_b32 v39, s24, v25, v39
    v_pk_mul_f32 v[58:59], v[58:59], v[30:31]
    v_pk_mul_f32 v[62:63], v[62:63], v[30:31]
    v_pk_mul_f32 v[66:67], v[66:67], v[30:31]
    v_pk_mul_f32 v[70:71], v[70:71], v[30:31]
    v_lshrrev_b32 v26, 4, v34
    v_cvt_pknorm_i16_f32 v40, v58, v62
    v_cvt_pknorm_i16_f32 v41, v66, v70
    v_lshrrev_b32 v27, 4, v35
    v_cvt_pknorm_i16_f32 v42, v59, v63
    v_cvt_pknorm_i16_f32 v43, v67, v71
    v_bfi_b32 v40, s24, v34, v40
    v_bfi_b32 v41, s24, v26, v41
    v_bfi_b32 v42, s24, v35, v42
    v_bfi_b32 v43, s24, v27, v43
    s_cmp_eq_u32 s19, 2
    s_cbranch_scc0 L_hs_69
    buffer_store_dwordx4 v[36:39], v82, s[36:39], s6 offen offset:0
    buffer_store_dwordx4 v[40:43], v82, s[36:39], s6 offen offset:256
    s_nop 0
    s_branch L_hd_70
L_hs_69:
    buffer_store_dwordx4 v[36:39], v82, s[36:39], s6 offen offset:0 sc1
    buffer_store_dwordx4 v[40:43], v82, s[36:39], s6 offen offset:256 sc1
L_hd_70:
    s_bitcmp1_b32 15, s3
    s_cselect_b32 s54, s66, -1
L_poll_73:
    buffer_load_dwordx4 v[184:187], v83, s[36:39], s9 offen sc1
    buffer_load_dwordx4 v[188:191], v83, s[36:39], s10 offen sc1
    s_waitcnt vmcnt(0)
    v_min3_i32 v80, v184, v185, v186
    v_min3_i32 v81, v187, v188, v189
    v_min3_i32 v80, v80, v190, v191
    v_min_i32 v80, v80, v81
    v_cmp_eq_u32 vcc, 0x80000000, v80
    s_nop 0
    s_cmp_eq_u64 vcc, 0
    s_cselect_b32 s52, 1, 0
    s_cmp_lg_u32 s54, s66
    s_cbranch_scc1 L_lg_74
    v_mov_b32 v14, s52
    ds_write_b32 v4, v14 offset:0
L_lg_74:
    s_cmp_eq_u32 s52, 1
    s_cbranch_scc1 L_done_72_0
    s_add_u32 s66, s66, 1
    s_cmp_lt_u32 s66, 200000
    s_cbranch_scc1 L_poll_73
L_done_72_0:
    v_and_b32 v24, s24, v184
    v_and_b32 v25, s24, v186
    v_and_b32 v26, s24, v188
    v_and_b32 v27, s24, v190
    v_and_b32 v28, s24, v185
    v_and_b32 v29, s24, v187
    v_and_b32 v30, s24, v189
    v_and_b32 v31, s24, v191
    v_bfi_b32 v32, s24, v17, v184
    v_bfi_b32 v33, s24, v17, v185
    v_bfi_b32 v34, s24, v17, v186
    v_bfi_b32 v35, s24, v17, v187
    v_bfi_b32 v36, s24, v17, v188
    v_bfi_b32 v37, s24, v17, v189
    v_bfi_b32 v38, s24, v17, v190
    v_bfi_b32 v39, s24, v17, v191
    v_lshl_or_b32 v24, v28, 4, v24
    v_lshl_or_b32 v25, v29, 4, v25
    v_lshl_or_b32 v26, v30, 4, v26
    v_lshl_or_b32 v27, v31, 4, v27
    v_mad_u32_u24 v24, v24, s27, v18
    v_mad_u32_u24 v25, v25, s27, v18
    v_mad_u32_u24 v26, v26, s27, v18
    v_mad_u32_u24 v27, v27, s27, v18
    v_and_b32 v24, s28, v24
    v_and_b32 v25, s28, v25
    v_and_b32 v26, s28, v26
    v_and_b32 v27, s28, v27
    v_cvt_f32_i32_sdwa v40, sext(v32) dst_sel:DWORD dst_unused:UNUSED_PAD src0_sel:WORD_0
    v_cvt_f32_i32_sdwa v42, sext(v32) dst_sel:DWORD dst_unused:UNUSED_PAD src0_sel:WORD_1
    v_cvt_f32_i32_sdwa v44, sext(v33) dst_sel:DWORD dst_unused:UNUSED_PAD src0_sel:WORD_0
    v_cvt_f32_i32_sdwa v46, sext(v33) dst_sel:DWORD dst_unused:UNUSED_PAD src0_sel:WORD_1
    v_cvt_f32_i32_sdwa v41, sext(v34) dst_sel:DWORD dst_unused:UNUSED_PAD src0_sel:WORD_0
    v_cvt_f32_i32_sdwa v43, sext(v34) dst_sel:DWORD dst_unused:UNUSED_PAD src0_sel:WORD_1
    v_cvt_f32_i32_sdwa v45, sext(v35) dst_sel:DWORD dst_unused:UNUSED_PAD src0_sel:WORD_0
    v_cvt_f32_i32_sdwa v47, sext(v35) dst_sel:DWORD dst_unused:UNUSED_PAD src0_sel:WORD_1
    v_cvt_f32_i32_sdwa v48, sext(v36) dst_sel:DWORD dst_unused:UNUSED_PAD src0_sel:WORD_0
    v_cvt_f32_i32_sdwa v50, sext(v36) dst_sel:DWORD dst_unused:UNUSED_PAD src0_sel:WORD_1
    v_cvt_f32_i32_sdwa v52, sext(v37) dst_sel:DWORD dst_unused:UNUSED_PAD src0_sel:WORD_0
    v_cvt_f32_i32_sdwa v54, sext(v37) dst_sel:DWORD dst_unused:UNUSED_PAD src0_sel:WORD_1
    v_cvt_f32_i32_sdwa v49, sext(v38) dst_sel:DWORD dst_unused:UNUSED_PAD src0_sel:WORD_0
    v_cvt_f32_i32_sdwa v51, sext(v38) dst_sel:DWORD dst_unused:UNUSED_PAD src0_sel:WORD_1
    v_cvt_f32_i32_sdwa v53, sext(v39) dst_sel:DWORD dst_unused:UNUSED_PAD src0_sel:WORD_0
    v_cvt_f32_i32_sdwa v55, sext(v39) dst_sel:DWORD dst_unused:UNUSED_PAD src0_sel:WORD_1
    v_pk_mul_f32 v[72:73], v[40:41], v[24:25]
    v_pk_mul_f32 v[74:75], v[42:43], v[24:25]
    v_pk_mul_f32 v[76:77], v[44:45], v[24:25]
    v_pk_mul_f32 v[78:79], v[46:47], v[24:25]
    v_pk_fma_f32 v[72:73], v[48:49], v[26:27], v[72:73]
    v_pk_fma_f32 v[74:75], v[50:51], v[26:27], v[74:75]
    v_pk_fma_f32 v[76:77], v[52:53], v[26:27], v[76:77]
    v_pk_fma_f32 v[78:79], v[54:55], v[26:27], v[78:79]
L_done_72:
    s_nop 0
    v_permlane32_swap_b32 v72, v76
    v_permlane32_swap_b32 v73, v77
    v_permlane32_swap_b32 v74, v78
    v_permlane32_swap_b32 v75, v79
    v_pk_add_f32 v[72:73], v[72:73], v[76:77]
    v_pk_add_f32 v[74:75], v[74:75], v[78:79]
    s_nop 1
    v_permlane16_swap_b32 v72, v74
    v_permlane16_swap_b32 v73, v75
    v_pk_add_f32 v[72:73], v[72:73], v[74:75]
    v_pk_mul_f32 v[72:73], v[72:73], s[30:31]
    v_cvt_pk_bf16_f32 v72, v72, v73
    v_min_u32 v72, -2, v72
    s_cmp_eq_u32 s19, 2
    s_cbranch_scc0 L_hs_75
    buffer_store_dword v72, v84, s[44:47], s14 offen
    s_branch L_hd_76
L_hs_75:
    buffer_store_dword v72, v84, s[44:47], s14 offen sc1
L_hd_76:
    s_lshl_b32 s52, s3, 11
    v_add_u32 v15, s52, v86
L_poll_77:
    buffer_load_dwordx4 v[232:235], v5, s[44:47], s13 offen offset:0 sc1
    buffer_load_dwordx4 v[236:239], v5, s[44:47], s13 offen offset:1024 sc1
    s_waitcnt vmcnt(0)
    v_max3_u32 v80, v232, v233, v234
    v_max3_u32 v80, v80, v235, v236
    v_max3_u32 v80, v80, v237, v238
    v_max_u32 v80, v80, v239
    ds_write_b128 v15, v[232:235]
    ds_write_b128 v15, v[236:239] offset:1024
    v_cmp_eq_u32 vcc, -1, v80
    s_nop 0
    s_cmp_eq_u64 vcc, 0
    s_nop 1
    s_cbranch_scc1 L_done_78
    s_add_u32 s66, s66, 1
    s_cmp_lt_u32 s66, 200000
    s_cbranch_scc1 L_poll_77
L_done_78:
L_kvd:
    v_mov_b32 v14, 1
    s_mov_b64 exec, 1
    ds_add_u32 v4, v14 offset:12
    s_mov_b64 exec, -1
    s_cmp_lg_u32 s3, 2
    s_cbranch_scc1 L_O01
    v_mov_b32 v14, 65536
    ds_write_b32 v4, v14 offset:52
L_O01:
    v_add_u32 v81, 8, v15
    ds_read2st64_b64 v[32:35], v15 offset0:0 offset1:0
    ds_read2st64_b64 v[36:39], v81 offset0:0 offset1:0
    ds_read2st64_b64 v[40:43], v15 offset0:2 offset1:2
    ds_read2st64_b64 v[44:47], v81 offset0:2 offset1:2
    v_add_u32 v15, 139264, v5
L_w_79:
    ds_read_b128 v[96:99], v4 offset:32
    s_waitcnt lgkmcnt(0)
    v_min3_u32 v96, v96, v97, v98
    v_min_u32 v96, v96, v99
    s_nop 0
    v_readfirstlane_b32 s55, v96
    s_nop 0
    s_cmp_ge_u32 s55, 1
    s_nop 1
    s_cbranch_scc1 L_wd_80
    s_sleep 2
    s_add_u32 s66, s66, 1
    s_cmp_lt_u32 s66, 200000
    s_cbranch_scc1 L_w_79
L_wd_80:
    ds_read_b128 v[16:19], v15 offset:0
    ds_read_b128 v[20:23], v15 offset:1024
    ds_read_b128 v[24:27], v15 offset:2048
    ds_read_b128 v[28:31], v15 offset:3072
    s_cmp_lt_u32 s55, 2
    s_cbranch_scc1 L_Oslow
    ds_read_b128 v[168:171], v15 offset:4096
    ds_read_b128 v[172:175], v15 offset:5120
    ds_read_b128 v[176:179], v15 offset:6144
    ds_read_b128 v[180:183], v15 offset:7168
    ds_read_b64 v[96:97], v4 offset:48
    s_waitcnt lgkmcnt(8)
    v_mfma_f32_16x16x32_bf16 v[48:51], v[16:19], v[32:35], 0
    v_mfma_f32_16x16x32_bf16 v[52:55], v[16:19], v[36:39], 0
    v_mfma_f32_16x16x32_bf16 v[56:59], v[16:19], v[40:43], 0
    v_mfma_f32_16x16x32_bf16 v[60:63], v[16:19], v[44:47], 0
    s_waitcnt lgkmcnt(7)
    v_mfma_f32_16x16x32_bf16 v[64:67], v[20:23], v[32:35], 0
    v_mfma_f32_16x16x32_bf16 v[68:71], v[20:23], v[36:39], 0
    v_mfma_f32_16x16x32_bf16 v[72:75], v[20:23], v[40:43], 0
    v_mfma_f32_16x16x32_bf16 v[76:79], v[20:23], v[44:47], 0
    s_nop 0
    v_cvt_pk_bf16_f32 v104, v48, v52
    s_nop 0
    v_cvt_pk_bf16_f32 v105, v56, v60
    v_cvt_pk_bf16_f32 v106, v49, v53
    v_cvt_pk_bf16_f32 v107, v57, v61
    v_cvt_pk_bf16_f32 v108, v50, v54
    v_cvt_pk_bf16_f32 v109, v58, v62
    v_cvt_pk_bf16_f32 v110, v51, v55
    v_cvt_pk_bf16_f32 v111, v59, v63
    s_waitcnt lgkmcnt(6)
    v_mfma_f32_16x16x32_bf16 v[48:51], v[24:27], v[32:35], 0
    v_mfma_f32_16x16x32_bf16 v[52:55], v[24:27], v[36:39], 0
    v_mfma_f32_16x16x32_bf16 v[56:59], v[24:27], v[40:43], 0
    v_mfma_f32_16x16x32_bf16 v[60:63], v[24:27], v[44:47], 0
    v_cvt_pk_bf16_f32 v112, v64, v68
    v_cvt_pk_bf16_f32 v113, v72, v76
    v_cvt_pk_bf16_f32 v114, v65, v69
    v_cvt_pk_bf16_f32 v115, v73, v77
    v_cvt_pk_bf16_f32 v116, v66, v70
    v_cvt_pk_bf16_f32 v117, v74, v78
    v_cvt_pk_bf16_f32 v118, v67, v71
    v_cvt_pk_bf16_f32 v119, v75, v79
    s_waitcnt lgkmcnt(5)
    v_mfma_f32_16x16x32_bf16 v[64:67], v[28:31], v[32:35], 0
    v_mfma_f32_16x16x32_bf16 v[68:71], v[28:31], v[36:39], 0
    v_mfma_f32_16x16x32_bf16 v[72:75], v[28:31], v[40:43], 0
    v_mfma_f32_16x16x32_bf16 v[76:79], v[28:31], v[44:47], 0
    v_cvt_pk_bf16_f32 v120, v48, v52
    v_cvt_pk_bf16_f32 v121, v56, v60
    v_cvt_pk_bf16_f32 v122, v49, v53
    v_cvt_pk_bf16_f32 v123, v57, v61
    v_cvt_pk_bf16_f32 v124, v50, v54
    v_cvt_pk_bf16_f32 v125, v58, v62
    v_cvt_pk_bf16_f32 v126, v51, v55
    v_cvt_pk_bf16_f32 v127, v59, v63
    s_waitcnt lgkmcnt(4)
    v_mfma_f32_16x16x32_bf16 v[48:51], v[168:171], v[32:35], 0
    v_mfma_f32_16x16x32_bf16 v[52:55], v[168:171], v[36:39], 0
    v_mfma_f32_16x16x32_bf16 v[56:59], v[168:171], v[40:43], 0
    v_mfma_f32_16x16x32_bf16 v[60:63], v[168:171], v[44:47], 0
    v_cvt_pk_bf16_f32 v128, v64, v68
    v_cvt_pk_bf16_f32 v129, v72, v76
    v_cvt_pk_bf16_f32 v130, v65, v69
    v_cvt_pk_bf16_f32 v131, v73, v77
    v_cvt_pk_bf16_f32 v132, v66, v70
    v_cvt_pk_bf16_f32 v133, v74, v78
    v_cvt_pk_bf16_f32 v134, v67, v71
    v_cvt_pk_bf16_f32 v135, v75, v79
    s_waitcnt lgkmcnt(3)
    v_mfma_f32_16x16x32_bf16 v[64:67], v[172:175], v[32:35], 0
    v_mfma_f32_16x16x32_bf16 v[68:71], v[172:175], v[36:39], 0
    v_mfma_f32_16x16x32_bf16 v[72:75], v[172:175], v[40:43], 0
    v_mfma_f32_16x16x32_bf16 v[76:79], v[172:175], v[44:47], 0
    v_cvt_pk_bf16_f32 v136, v48, v52
    v_cvt_pk_bf16_f32 v137, v56, v60
    v_cvt_pk_bf16_f32 v138, v49, v53
    v_cvt_pk_bf16_f32 v139, v57, v61
    v_cvt_pk_bf16_f32 v140, v50, v54
    v_cvt_pk_bf16_f32 v141, v58, v62
    v_cvt_pk_bf16_f32 v142, v51, v55
    v_cvt_pk_bf16_f32 v143, v59, v63
    s_waitcnt lgkmcnt(2)
    v_mfma_f32_16x16x32_bf16 v[48:51], v[176:179], v[32:35], 0
    v_mfma_f32_16x16x32_bf16 v[52:55], v[176:179], v[36:39], 0
    v_mfma_f32_16x16x32_bf16 v[56:59], v[176:179], v[40:43], 0
    v_mfma_f32_16x16x32_bf16 v[60:63], v[176:179], v[44:47], 0
    v_cvt_pk_bf16_f32 v144, v64, v68
    v_cvt_pk_bf16_f32 v145, v72, v76
    v_cvt_pk_bf16_f32 v146, v65, v69
    v_cvt_pk_bf16_f32 v147, v73, v77
    v_cvt_pk_bf16_f32 v148, v66, v70
    v_cvt_pk_bf16_f32 v149, v74, v78
    v_cvt_pk_bf16_f32 v150, v67, v71
    v_cvt_pk_bf16_f32 v151, v75, v79
    s_waitcnt lgkmcnt(0)
    v_mfma_f32_16x16x32_bf16 v[64:67], v[180:183], v[32:35], 0
    v_mfma_f32_16x16x32_bf16 v[68:71], v[180:183], v[36:39], 0
    v_mfma_f32_16x16x32_bf16 v[72:75], v[180:183], v[40:43], 0
    v_mfma_f32_16x16x32_bf16 v[76:79], v[180:183], v[44:47], 0
    v_cvt_pk_bf16_f32 v152, v48, v52
    v_cvt_pk_bf16_f32 v153, v56, v60
    v_cvt_pk_bf16_f32 v154, v49, v53
    v_cvt_pk_bf16_f32 v155, v57, v61
    v_cvt_pk_bf16_f32 v156, v50, v54
    v_cvt_pk_bf16_f32 v157, v58, v62
    v_cvt_pk_bf16_f32 v158, v51, v55
    v_cvt_pk_bf16_f32 v159, v59, v63
    v_min_u32 v96, v96, v97
    s_nop 0
    v_readfirstlane_b32 s55, v96
    v_cvt_pk_bf16_f32 v160, v64, v68
    v_cvt_pk_bf16_f32 v161, v72, v76
    v_cvt_pk_bf16_f32 v162, v65, v69
    v_cvt_pk_bf16_f32 v163, v73, v77
    v_cvt_pk_bf16_f32 v164, v66, v70
    v_cvt_pk_bf16_f32 v165, v74, v78
    v_cvt_pk_bf16_f32 v166, v67, v71
    v_cvt_pk_bf16_f32 v167, v75, v79
    s_cmp_ge_u32 s55, 268
    s_cbranch_scc1 L_Ost
    s_branch L_Ogate
L_Oslow:
    s_waitcnt lgkmcnt(3)
    v_mfma_f32_16x16x32_bf16 v[48:51], v[16:19], v[32:35], 0
    v_mfma_f32_16x16x32_bf16 v[52:55], v[16:19], v[36:39], 0
    v_mfma_f32_16x16x32_bf16 v[56:59], v[16:19], v[40:43], 0
    v_mfma_f32_16x16x32_bf16 v[60:63], v[16:19], v[44:47], 0
    s_waitcnt lgkmcnt(2)
    v_mfma_f32_16x16x32_bf16 v[64:67], v[20:23], v[32:35], 0
    v_mfma_f32_16x16x32_bf16 v[68:71], v[20:23], v[36:39], 0
    v_mfma_f32_16x16x32_bf16 v[72:75], v[20:23], v[40:43], 0
    v_mfma_f32_16x16x32_bf16 v[76:79], v[20:23], v[44:47], 0
    s_nop 0
    v_cvt_pk_bf16_f32 v104, v48, v52
    s_nop 0
    v_cvt_pk_bf16_f32 v105, v56, v60
    v_cvt_pk_bf16_f32 v106, v49, v53
    v_cvt_pk_bf16_f32 v107, v57, v61
    v_cvt_pk_bf16_f32 v108, v50, v54
    v_cvt_pk_bf16_f32 v109, v58, v62
    v_cvt_pk_bf16_f32 v110, v51, v55
    v_cvt_pk_bf16_f32 v111, v59, v63
    s_waitcnt lgkmcnt(1)
    v_mfma_f32_16x16x32_bf16 v[48:51], v[24:27], v[32:35], 0
    v_mfma_f32_16x16x32_bf16 v[52:55], v[24:27], v[36:39], 0
    v_mfma_f32_16x16x32_bf16 v[56:59], v[24:27], v[40:43], 0
    v_mfma_f32_16x16x32_bf16 v[60:63], v[24:27], v[44:47], 0
    v_cvt_pk_bf16_f32 v112, v64, v68
    v_cvt_pk_bf16_f32 v113, v72, v76
    v_cvt_pk_bf16_f32 v114, v65, v69
    v_cvt_pk_bf16_f32 v115, v73, v77
    v_cvt_pk_bf16_f32 v116, v66, v70
    v_cvt_pk_bf16_f32 v117, v74, v78
    v_cvt_pk_bf16_f32 v118, v67, v71
    v_cvt_pk_bf16_f32 v119, v75, v79
    s_waitcnt lgkmcnt(0)
    v_mfma_f32_16x16x32_bf16 v[64:67], v[28:31], v[32:35], 0
    v_mfma_f32_16x16x32_bf16 v[68:71], v[28:31], v[36:39], 0
    v_mfma_f32_16x16x32_bf16 v[72:75], v[28:31], v[40:43], 0
    v_mfma_f32_16x16x32_bf16 v[76:79], v[28:31], v[44:47], 0
    v_cvt_pk_bf16_f32 v120, v48, v52
    v_cvt_pk_bf16_f32 v121, v56, v60
    v_cvt_pk_bf16_f32 v122, v49, v53
    v_cvt_pk_bf16_f32 v123, v57, v61
    v_cvt_pk_bf16_f32 v124, v50, v54
    v_cvt_pk_bf16_f32 v125, v58, v62
    v_cvt_pk_bf16_f32 v126, v51, v55
    v_cvt_pk_bf16_f32 v127, v59, v63
    v_cvt_pk_bf16_f32 v128, v64, v68
    v_cvt_pk_bf16_f32 v129, v72, v76
    v_cvt_pk_bf16_f32 v130, v65, v69
    v_cvt_pk_bf16_f32 v131, v73, v77
    v_cvt_pk_bf16_f32 v132, v66, v70
    v_cvt_pk_bf16_f32 v133, v74, v78
    v_cvt_pk_bf16_f32 v134, v67, v71
    v_cvt_pk_bf16_f32 v135, v75, v79
L_w_81:
    ds_read_b128 v[96:99], v4 offset:32
    s_waitcnt lgkmcnt(0)
    v_min3_u32 v96, v96, v97, v98
    v_min_u32 v96, v96, v99
    s_nop 0
    v_readfirstlane_b32 s55, v96
    s_nop 0
    s_cmp_ge_u32 s55, 2
    s_nop 1
    s_cbranch_scc1 L_wd_82
    s_sleep 2
    s_add_u32 s66, s66, 1
    s_cmp_lt_u32 s66, 200000
    s_cbranch_scc1 L_w_81
L_wd_82:
    ds_read_b128 v[16:19], v15 offset:4096
    ds_read_b128 v[20:23], v15 offset:5120
    ds_read_b128 v[24:27], v15 offset:6144
    ds_read_b128 v[28:31], v15 offset:7168
    s_waitcnt lgkmcnt(3)
    v_mfma_f32_16x16x32_bf16 v[48:51], v[16:19], v[32:35], 0
    v_mfma_f32_16x16x32_bf16 v[52:55], v[16:19], v[36:39], 0
    v_mfma_f32_16x16x32_bf16 v[56:59], v[16:19], v[40:43], 0
    v_mfma_f32_16x16x32_bf16 v[60:63], v[16:19], v[44:47], 0
    s_waitcnt lgkmcnt(2)
    v_mfma_f32_16x16x32_bf16 v[64:67], v[20:23], v[32:35], 0
    v_mfma_f32_16x16x32_bf16 v[68:71], v[20:23], v[36:39], 0
    v_mfma_f32_16x16x32_bf16 v[72:75], v[20:23], v[40:43], 0
    v_mfma_f32_16x16x32_bf16 v[76:79], v[20:23], v[44:47], 0
    s_nop 0
    v_cvt_pk_bf16_f32 v136, v48, v52
    s_nop 0
    v_cvt_pk_bf16_f32 v137, v56, v60
    v_cvt_pk_bf16_f32 v138, v49, v53
    v_cvt_pk_bf16_f32 v139, v57, v61
    v_cvt_pk_bf16_f32 v140, v50, v54
    v_cvt_pk_bf16_f32 v141, v58, v62
    v_cvt_pk_bf16_f32 v142, v51, v55
    v_cvt_pk_bf16_f32 v143, v59, v63
    s_waitcnt lgkmcnt(1)
    v_mfma_f32_16x16x32_bf16 v[48:51], v[24:27], v[32:35], 0
    v_mfma_f32_16x16x32_bf16 v[52:55], v[24:27], v[36:39], 0
    v_mfma_f32_16x16x32_bf16 v[56:59], v[24:27], v[40:43], 0
    v_mfma_f32_16x16x32_bf16 v[60:63], v[24:27], v[44:47], 0
    v_cvt_pk_bf16_f32 v144, v64, v68
    v_cvt_pk_bf16_f32 v145, v72, v76
    v_cvt_pk_bf16_f32 v146, v65, v69
    v_cvt_pk_bf16_f32 v147, v73, v77
    v_cvt_pk_bf16_f32 v148, v66, v70
    v_cvt_pk_bf16_f32 v149, v74, v78
    v_cvt_pk_bf16_f32 v150, v67, v71
    v_cvt_pk_bf16_f32 v151, v75, v79
    s_waitcnt lgkmcnt(0)
    v_mfma_f32_16x16x32_bf16 v[64:67], v[28:31], v[32:35], 0
    v_mfma_f32_16x16x32_bf16 v[68:71], v[28:31], v[36:39], 0
    v_mfma_f32_16x16x32_bf16 v[72:75], v[28:31], v[40:43], 0
    v_mfma_f32_16x16x32_bf16 v[76:79], v[28:31], v[44:47], 0
    v_cvt_pk_bf16_f32 v152, v48, v52
    v_cvt_pk_bf16_f32 v153, v56, v60
    v_cvt_pk_bf16_f32 v154, v49, v53
    v_cvt_pk_bf16_f32 v155, v57, v61
    v_cvt_pk_bf16_f32 v156, v50, v54
    v_cvt_pk_bf16_f32 v157, v58, v62
    v_cvt_pk_bf16_f32 v158, v51, v55
    v_cvt_pk_bf16_f32 v159, v59, v63
    v_cvt_pk_bf16_f32 v160, v64, v68
    v_cvt_pk_bf16_f32 v161, v72, v76
    v_cvt_pk_bf16_f32 v162, v65, v69
    v_cvt_pk_bf16_f32 v163, v73, v77
    v_cvt_pk_bf16_f32 v164, v66, v70
    v_cvt_pk_bf16_f32 v165, v74, v78
    v_cvt_pk_bf16_f32 v166, v67, v71
    v_cvt_pk_bf16_f32 v167, v75, v79
L_Ogate:
L_w_83:
    ds_read_b64 v[96:97], v4 offset:48
    s_waitcnt lgkmcnt(0)
    v_min_u32 v96, v96, v97
    s_nop 0
    v_readfirstlane_b32 s55, v96
    s_nop 0
    s_cmp_ge_u32 s55, 268
    s_nop 1
    s_cbranch_scc1 L_wd_84
    s_sleep 2
    s_add_u32 s66, s66, 1
    s_cmp_lt_u32 s66, 200000
    s_cbranch_scc1 L_w_83
L_wd_84:
L_Ost:
    s_add_u32 s67, s61, 0
    buffer_store_dwordx2 v[104:105], v3, s[36:39], s67 offen offset:0 nt
    buffer_store_dwordx2 v[106:107], v3, s[36:39], s67 offen offset:384 nt
    buffer_store_dwordx2 v[108:109], v3, s[36:39], s67 offen offset:768 nt
    buffer_store_dwordx2 v[110:111], v3, s[36:39], s67 offen offset:1152 nt
    s_add_u32 s67, s61, 6144
    buffer_store_dwordx2 v[112:113], v3, s[36:39], s67 offen offset:0 nt
    buffer_store_dwordx2 v[114:115], v3, s[36:39], s67 offen offset:384 nt
    buffer_store_dwordx2 v[116:117], v3, s[36:39], s67 offen offset:768 nt
    buffer_store_dwordx2 v[118:119], v3, s[36:39], s67 offen offset:1152 nt
    s_add_u32 s67, s61, 12288
    buffer_store_dwordx2 v[120:121], v3, s[36:39], s67 offen offset:0 nt
    buffer_store_dwordx2 v[122:123], v3, s[36:39], s67 offen offset:384 nt
    buffer_store_dwordx2 v[124:125], v3, s[36:39], s67 offen offset:768 nt
    buffer_store_dwordx2 v[126:127], v3, s[36:39], s67 offen offset:1152 nt
    s_add_u32 s67, s61, 18432
    buffer_store_dwordx2 v[128:129], v3, s[36:39], s67 offen offset:0 nt
    buffer_store_dwordx2 v[130:131], v3, s[36:39], s67 offen offset:384 nt
    buffer_store_dwordx2 v[132:133], v3, s[36:39], s67 offen offset:768 nt
    buffer_store_dwordx2 v[134:135], v3, s[36:39], s67 offen offset:1152 nt
    s_add_u32 s67, s61, 24576
    buffer_store_dwordx2 v[136:137], v3, s[36:39], s67 offen offset:0 nt
    buffer_store_dwordx2 v[138:139], v3, s[36:39], s67 offen offset:384 nt
    buffer_store_dwordx2 v[140:141], v3, s[36:39], s67 offen offset:768 nt
    buffer_store_dwordx2 v[142:143], v3, s[36:39], s67 offen offset:1152 nt
    s_add_u32 s67, s61, 30720
    buffer_store_dwordx2 v[144:145], v3, s[36:39], s67 offen offset:0 nt
    buffer_store_dwordx2 v[146:147], v3, s[36:39], s67 offen offset:384 nt
    buffer_store_dwordx2 v[148:149], v3, s[36:39], s67 offen offset:768 nt
    buffer_store_dwordx2 v[150:151], v3, s[36:39], s67 offen offset:1152 nt
    s_add_u32 s67, s61, 36864
    buffer_store_dwordx2 v[152:153], v3, s[36:39], s67 offen offset:0 nt
    buffer_store_dwordx2 v[154:155], v3, s[36:39], s67 offen offset:384 nt
    buffer_store_dwordx2 v[156:157], v3, s[36:39], s67 offen offset:768 nt
    buffer_store_dwordx2 v[158:159], v3, s[36:39], s67 offen offset:1152 nt
    s_add_u32 s67, s61, 43008
    buffer_store_dwordx2 v[160:161], v3, s[36:39], s67 offen offset:0 nt
    buffer_store_dwordx2 v[162:163], v3, s[36:39], s67 offen offset:384 nt
    buffer_store_dwordx2 v[164:165], v3, s[36:39], s67 offen offset:768 nt
    buffer_store_dwordx2 v[166:167], v3, s[36:39], s67 offen offset:1152 nt
L_fin:
L_end:
    s_endpgm
.section .rodata,"a"
.p2align 6
.amdhsa_kernel standalone__linear_kernel_rfa__prompt_kernel
  .amdhsa_next_free_vgpr 256
  .amdhsa_next_free_sgpr 102
  .amdhsa_accum_offset 256
  .amdhsa_group_segment_fixed_size 0
  .amdhsa_kernarg_size 56
  .amdhsa_user_sgpr_count 2
  .amdhsa_user_sgpr_kernarg_segment_ptr 1
  .amdhsa_system_sgpr_workgroup_id_x 1
.end_amdhsa_kernel
```
